```python
import torch

def _softmax(x, axis=-1):
    return torch.softmax(x, dim=axis)
def _gelu(x):
    return torch.nn.functional.gelu(x, approximate="tanh")
def _silu(x):
    return torch.nn.functional.silu(x)
def _sigmoid(x):
    return torch.sigmoid(x)
def _layernorm(x, axis=-1, eps=1e-5):
    m = x.mean(dim=axis, keepdim=True)
    v = x.var(dim=axis, keepdim=True, unbiased=False)
    return (x - m) / torch.sqrt(v + eps)
def _scatter_add(tgt, idx, src, axis=0):
    return tgt.clone().index_add_(axis, idx, src)
def _segment_sum(src, seg, n):
    out = torch.zeros((n,) + src.shape[1:], dtype=src.dtype)
    return out.index_add_(0, seg, src)
def _pad(x, pw):
    flat = tuple(v for pair in reversed(pw) for v in pair)
    return torch.nn.functional.pad(x, flat)

kernel_name = 'recurrent_scan__ssm_conv_h3__moe_arch_mod__prompt'

def setup_inputs():

    _w = (lambda a: (lambda t: t.to(torch.bfloat16) if t.is_floating_point() else t)(torch.as_tensor(a)))
    def _A_setup():
        B, S, D = 1, 2048, 1024
        ks = 4
        return {
            "q": _w((lambda *s: torch.randn(*s, dtype=torch.bfloat16) * 0.05)(B, S, D)),
            "k": _w((lambda *s: torch.randn(*s, dtype=torch.bfloat16) * 0.2)(B, S, D)),
            "v": _w((lambda *s: torch.randn(*s, dtype=torch.bfloat16) * 0.2)(B, S, D)),
            "shift_k": _w((lambda *s: torch.randn(*s, dtype=torch.bfloat16) * 0.2)(D, ks) * 0.5),
            "ssm_k": _w((lambda *s: torch.randn(*s, dtype=torch.bfloat16) * 0.2)(D, S) * (1.0 / S ** 0.5)),
            "ssm_D": _w((lambda *s: torch.randn(*s, dtype=torch.bfloat16) * 0.2)(D)),
        }
    _A_in = _A_setup()

    def _B_setup():
        B, S, D, F, C = 1, 2048, 1024, 3584, 2
        return {
            "x": _w((lambda *s: torch.randn(*s, dtype=torch.bfloat16) * 0.05)(B, S, D)),
            "w_r": _w((lambda *s: torch.randn(*s, dtype=torch.bfloat16) * 0.2)(D)),
            "w_gate": _w((lambda *s: torch.randn(*s, dtype=torch.bfloat16) * 0.1)(D, F)),
            "w_up": _w((lambda *s: torch.randn(*s, dtype=torch.bfloat16) * 0.1)(D, F)),
            "w_down": _w((lambda *s: torch.randn(*s, dtype=torch.bfloat16) * 0.1)(F, D)),
        }
    _B_in = _B_setup()

    return {
        "A_q": _A_in["q"],
        "A_k": _A_in["k"],
        "A_v": _A_in["v"],
        "A_shift_k": _A_in["shift_k"],
        "A_ssm_k": _A_in["ssm_k"],
        "A_ssm_D": _A_in["ssm_D"],
        "B_x": _B_in["x"],
        "B_w_r": _B_in["w_r"],
        "B_w_gate": _B_in["w_gate"],
        "B_w_up": _B_in["w_up"],
        "B_w_down": _B_in["w_down"],
    }

def reference(A_q, A_k, A_v, A_shift_k, A_ssm_k, A_ssm_D, B_x, B_w_r, B_w_gate, B_w_up, B_w_down):
    def _A_ref(q, k, v, shift_k, ssm_k, ssm_D):
        B, S, D = q.shape
        ks = shift_k.shape[-1]
        k_pad = _pad(k, ((0, 0), (ks - 1, 0), (0, 0)))
        k_shift = torch.zeros_like(k)
        for t in range(ks):
            k_shift = k_shift + k_pad[:, t:t + S, :] * shift_k[:, ks - 1 - t][None, None, :]
        kv = k_shift * v
        L = 2 * S
        kv_pad = _pad(kv, ((0, 0), (0, S), (0, 0)))
        kf_pad = _pad(ssm_k, ((0, 0), (0, S)))
        kv_f = (lambda x, axes=(-2,-1): torch.fft.rfft2(x.float(), dim=axes))(kv_pad[:, None, :, :], axes=(1, 2))
        kf_f = (lambda x, axes=(-2,-1): torch.fft.rfft2(x.float(), dim=axes))(kf_pad[:, None, :], axes=(1, 2))
        kf_f = (lambda x, *d: x.permute(*d))(kf_f, 1, 2, 0)
        y_f = kv_f * kf_f[None, :, :, :]
        y = (lambda x, s, axes=(-2,-1): torch.fft.irfft2(x, s=s, dim=axes).to(torch.bfloat16))(y_f, (1, L), axes=(1, 2))[:, 0, :S, :]
        y = y + kv * ssm_D[None, None, :]
        return q * y

    def _B_ref(x, w_r, w_gate, w_up, w_down):
        B, S, D = x.shape
        C = 2
        r = x @ w_r
        idx = torch.argsort(-r, axis=-1)[:, :C]
        idx_e = (lambda x, n, axis: torch.repeat_interleave(x, n, dim=axis))(idx.reshape(B, C, 1), D, axis=2)
        x_sel = (lambda x, i, axis: torch.take_along_dim(x, i, dim=axis))(x, idx_e, axis=1)
        g = _silu(x_sel @ w_gate)
        u = x_sel @ w_up
        y = (g * u) @ w_down
        r_sel = _sigmoid((lambda x, i, axis: torch.take_along_dim(x, i, dim=axis))(r, idx, axis=1))
        y = y * r_sel.reshape(B, C, 1)
        b_off = (torch.arange(B) * S).reshape(B, 1)
        flat_idx = (idx + b_off).reshape(B * C)
        zero = (x * 0.0).reshape(B * S, D)
        upd = _scatter_add(zero, flat_idx, y.reshape(B * C, D), axis=0)
        return x + upd.reshape(B, S, D)

    x = A_q
    xn = _layernorm(x, axis=-1)
    s = _A_ref(xn, A_k, A_v, A_shift_k, A_ssm_k, A_ssm_D)
    g = _silu(_B_ref(xn, B_w_r, B_w_gate, B_w_up, B_w_down))
    return x + s * g
```

```asm
; @launch grid=(256,1,1) block=(512,1,1) lds=160672
.amdgcn_target "amdgcn-amd-amdhsa--gfx950"
.text
.globl recurrent_scan__ssm_conv_h3__moe_arch_mod__prompt_kernel
.p2align 8
.type recurrent_scan__ssm_conv_h3__moe_arch_mod__prompt_kernel,@function
recurrent_scan__ssm_conv_h3__moe_arch_mod__prompt_kernel:
    s_cmp_ge_u32 s2, 256
    s_cbranch_scc1 L_end
    s_load_dwordx16 s[4:19], s[0:1], 0
    s_load_dwordx8 s[20:27], s[0:1], 64
    s_load_dwordx4 s[28:31], s[0:1], 96
    v_lshrrev_b32 v1, 6, v0
    v_mov_b32 v2, 158960
    v_mov_b32 v3, 1
    v_readfirstlane_b32 s3, v1
    v_and_b32 v1, 63, v0
    v_and_b32 v0, 255, v0
    v_lshlrev_b32 v5, 2, v1
    v_and_b32 v4, 28, v5
    v_mov_b32 v8, 0
    v_add_u32 v4, v4, v2
    ds_write_b32 v4, v8
    s_mov_b32 s88, 4096
    s_mov_b32 s89, 8192
    s_mov_b32 s90, 12288
    s_mov_b32 s93, 0xffff0000
    s_mov_b32 s94, 0x3f803f80
    s_and_b32 s92, s2, 7
    s_lshr_b32 s97, s2, 3
    s_mov_b32 s98, s2
    s_lshl_b32 s91, s92, 5
    s_add_u32 s2, s91, s97
    s_mul_i32 s92, s92, 28
    s_add_u32 s97, s97, s92
    s_lshl_b32 s95, s2, 14
    s_mul_i32 s96, s2, 24576
    v_lshl_add_u32 v6, v0, 3, s95
    v_lshl_add_u32 v7, v0, 4, s96
    v_mov_b32 v12, -1
    v_mov_b32 v13, -1
    v_mov_b32 v14, -1
    v_mov_b32 v15, -1
    s_mov_b32 s99, 6356992
    s_waitcnt lgkmcnt(0)
    s_barrier
    s_mov_b32 s0, s98
    s_mov_b32 s56, s30
    s_and_b32 s57, s31, 0xffff
    s_mov_b32 s58, 268435456
    s_mov_b32 s59, 0x00020000
    s_cmp_ge_u32 s3, 4
    s_cbranch_scc1 L_aux
    s_mov_b32 s32, s6
    s_and_b32 s33, s7, 0xffff
    s_mov_b32 s34, 4194304
    s_mov_b32 s35, 0x00020000
    v_lshlrev_b32 v10, 2, v0
    s_lshl2_add_u32 s98, s2, s99
    buffer_load_dword v174, v10, s[56:59], s99 offen
    buffer_load_dword v200, off, s[56:59], s98
    v_add_u32 v8, -6144, v6
    s_cmp_eq_u32 s2, 0
    s_cselect_b32 s92, 2147483648, 0
    v_max_i32 v8, 0, v8
    v_or_b32 v8, s92, v8
    s_mov_b32 s40, s10
    s_and_b32 s41, s11, 0xffff
    s_mov_b32 s42, 8192
    s_mov_b32 s43, 0x00020000
    v_lshlrev_b32 v9, 5, v0
    buffer_load_dwordx4 v[54:57], v9, s[40:43], 0 offen
    buffer_load_dwordx4 v[58:61], v9, s[40:43], 0 offen offset:16
    buffer_load_dwordx2 v[16:17], v8, s[32:35], 0 offen nt
    buffer_load_dwordx2 v[18:19], v8, s[32:35], 0 offen offset:2048 nt
    buffer_load_dwordx2 v[20:21], v8, s[32:35], s88 offen nt
    buffer_load_dwordx2 v[22:23], v6, s[32:35], 0 offen nt
    buffer_load_dwordx2 v[24:25], v6, s[32:35], 0 offen offset:2048 nt
    buffer_load_dwordx2 v[26:27], v6, s[32:35], s88 offen nt
    buffer_load_dwordx2 v[28:29], v6, s[32:35], s88 offen offset:2048 nt
    buffer_load_dwordx2 v[30:31], v6, s[32:35], s89 offen nt
    buffer_load_dwordx2 v[32:33], v6, s[32:35], s89 offen offset:2048 nt
    buffer_load_dwordx2 v[34:35], v6, s[32:35], s90 offen nt
    buffer_load_dwordx2 v[36:37], v6, s[32:35], s90 offen offset:2048 nt
    s_mov_b32 s36, s8
    s_and_b32 s37, s9, 0xffff
    s_mov_b32 s38, 4194304
    s_mov_b32 s39, 0x00020000
    buffer_load_dwordx2 v[38:39], v6, s[36:39], 0 offen
    buffer_load_dwordx2 v[40:41], v6, s[36:39], 0 offen offset:2048
    buffer_load_dwordx2 v[42:43], v6, s[36:39], s88 offen
    buffer_load_dwordx2 v[44:45], v6, s[36:39], s88 offen offset:2048
    buffer_load_dwordx2 v[46:47], v6, s[36:39], s89 offen
    buffer_load_dwordx2 v[48:49], v6, s[36:39], s89 offen offset:2048
    buffer_load_dwordx2 v[50:51], v6, s[36:39], s90 offen
    buffer_load_dwordx2 v[52:53], v6, s[36:39], s90 offen offset:2048
    s_mov_b32 s44, s12
    s_and_b32 s45, s13, 0xffff
    s_mov_b32 s46, 4194304
    s_mov_b32 s47, 0x00020000
    s_mov_b32 s48, s14
    s_and_b32 s49, s15, 0xffff
    s_mov_b32 s50, 2048
    s_mov_b32 s51, 0x00020000
    s_mov_b32 s52, s24
    s_and_b32 s53, s25, 0xffff
    s_mov_b32 s54, 7340032
    s_mov_b32 s55, 0x00020000
    s_mov_b32 s80, s28
    s_and_b32 s81, s29, 0xffff
    s_mov_b32 s82, 256
    s_mov_b32 s83, 0x00020000
    s_mov_b32 s84, s26
    s_and_b32 s85, s27, 0xffff
    s_mov_b32 s86, 4194304
    s_mov_b32 s87, 0x00020000
    s_mov_b32 s76, s4
    s_and_b32 s77, s5, 0xffff
    s_mov_b32 s78, 4194304
    s_mov_b32 s79, 0x00020000
    v_mov_b32 v12, 0
    v_mov_b32 v13, 0
    s_mul_i32 s98, s3, 16640
    s_mul_i32 s99, s3, 4640
    s_add_u32 s99, s99, 66560
    v_lshl_add_u32 v10, v1, 3, s99
    ds_write_b64 v10, v[12:13]
    v_and_b32 v10, 7, v1
    v_bfe_u32 v11, v1, 3, 2
    v_mul_u32_u24 v11, 4160, v11
    v_lshl_add_u32 v10, v10, 2, v11
    v_add_u32 v10, s98, v10
    ds_write_b32 v10, v12
    s_lshr_b32 s92, s2, 2
    s_lshl_b32 s92, s92, 4
    s_and_b32 s100, s2, 3
    s_add_u32 s100, s100, s92
    s_lshl2_add_u32 s101, s3, s100
    s_lshl_b32 s92, s101, 12
    v_lshl_add_u32 v10, v1, 4, s92
    v_add_u32 v11, -8, v10
    v_cmp_eq_u32 vcc, 0, v1
    s_nop 1
    v_cndmask_b32 v9, v11, v3, vcc
    v_cndmask_b32 v4, 0, v3, vcc
    v_lshl_or_b32 v9, v4, 31, v9
    v_add_u32 v11, 1024, v11
    s_lshl_b32 s92, s101, 1
    v_mov_b32 v8, s92
    s_mov_b32 s8, 0xaaaaaaaa
    s_mov_b32 s9, s8
    s_mov_b32 s10, 0xcccccccc
    s_mov_b32 s11, s10
    s_mov_b32 s16, 2654370226
    s_mov_b32 s17, 2135605598
    s_mov_b32 s18, 3535070886
    s_mov_b32 s19, 1540551562
    s_waitcnt vmcnt(8)
    v_readfirstlane_b32 s13, v200
    v_lshlrev_b32 v62, 16, v54
    v_and_b32 v66, s93, v54
    v_lshlrev_b32 v70, 16, v55
    v_and_b32 v74, s93, v55
    v_lshlrev_b32 v63, 16, v56
    v_and_b32 v67, s93, v56
    v_lshlrev_b32 v71, 16, v57
    v_and_b32 v75, s93, v57
    v_lshlrev_b32 v64, 16, v58
    v_and_b32 v68, s93, v58
    v_lshlrev_b32 v72, 16, v59
    v_and_b32 v76, s93, v59
    v_lshlrev_b32 v65, 16, v60
    v_and_b32 v69, s93, v60
    v_lshlrev_b32 v73, 16, v61
    v_and_b32 v77, s93, v61
    v_lshlrev_b32 v78, 16, v16
    v_and_b32 v79, s93, v16
    v_lshlrev_b32 v80, 16, v17
    v_and_b32 v81, s93, v17
    v_lshlrev_b32 v82, 16, v18
    v_and_b32 v83, s93, v18
    v_lshlrev_b32 v84, 16, v19
    v_and_b32 v85, s93, v19
    v_lshlrev_b32 v86, 16, v20
    v_and_b32 v87, s93, v20
    v_lshlrev_b32 v88, 16, v21
    v_and_b32 v89, s93, v21
    v_lshlrev_b32 v90, 16, v22
    v_and_b32 v91, s93, v22
    v_lshlrev_b32 v92, 16, v23
    v_and_b32 v93, s93, v23
    v_lshlrev_b32 v94, 16, v24
    v_and_b32 v95, s93, v24
    v_lshlrev_b32 v96, 16, v25
    v_and_b32 v97, s93, v25
    v_lshlrev_b32 v98, 16, v26
    v_and_b32 v99, s93, v26
    v_lshlrev_b32 v100, 16, v27
    v_and_b32 v101, s93, v27
    v_lshlrev_b32 v102, 16, v28
    v_and_b32 v103, s93, v28
    v_lshlrev_b32 v104, 16, v29
    v_and_b32 v105, s93, v29
    v_lshlrev_b32 v106, 16, v30
    v_and_b32 v107, s93, v30
    v_lshlrev_b32 v108, 16, v31
    v_and_b32 v109, s93, v31
    v_lshlrev_b32 v110, 16, v32
    v_and_b32 v111, s93, v32
    v_lshlrev_b32 v112, 16, v33
    v_and_b32 v113, s93, v33
    v_lshlrev_b32 v114, 16, v34
    v_and_b32 v115, s93, v34
    v_lshlrev_b32 v116, 16, v35
    v_and_b32 v117, s93, v35
    v_lshlrev_b32 v118, 16, v36
    v_and_b32 v119, s93, v36
    v_lshlrev_b32 v120, 16, v37
    v_and_b32 v121, s93, v37
    v_pk_mul_f32 v[122:123], v[78:79], v[74:75]
    v_pk_mul_f32 v[124:125], v[80:81], v[76:77]
    v_pk_mul_f32 v[126:127], v[82:83], v[74:75]
    v_pk_mul_f32 v[128:129], v[84:85], v[76:77]
    v_pk_mul_f32 v[130:131], v[86:87], v[74:75]
    v_pk_mul_f32 v[132:133], v[88:89], v[76:77]
    v_pk_mul_f32 v[134:135], v[90:91], v[74:75]
    v_pk_mul_f32 v[136:137], v[92:93], v[76:77]
    v_pk_mul_f32 v[138:139], v[94:95], v[74:75]
    v_pk_mul_f32 v[140:141], v[96:97], v[76:77]
    v_pk_mul_f32 v[142:143], v[98:99], v[74:75]
    v_pk_mul_f32 v[144:145], v[100:101], v[76:77]
    v_pk_mul_f32 v[146:147], v[102:103], v[74:75]
    v_pk_mul_f32 v[148:149], v[104:105], v[76:77]
    v_pk_mul_f32 v[150:151], v[106:107], v[74:75]
    v_pk_mul_f32 v[152:153], v[108:109], v[76:77]
    v_pk_fma_f32 v[122:123], v[82:83], v[70:71], v[122:123]
    v_pk_fma_f32 v[124:125], v[84:85], v[72:73], v[124:125]
    v_pk_fma_f32 v[126:127], v[86:87], v[70:71], v[126:127]
    v_pk_fma_f32 v[128:129], v[88:89], v[72:73], v[128:129]
    v_pk_fma_f32 v[130:131], v[90:91], v[70:71], v[130:131]
    v_pk_fma_f32 v[132:133], v[92:93], v[72:73], v[132:133]
    v_pk_fma_f32 v[134:135], v[94:95], v[70:71], v[134:135]
    v_pk_fma_f32 v[136:137], v[96:97], v[72:73], v[136:137]
    v_pk_fma_f32 v[138:139], v[98:99], v[70:71], v[138:139]
    v_pk_fma_f32 v[140:141], v[100:101], v[72:73], v[140:141]
    v_pk_fma_f32 v[142:143], v[102:103], v[70:71], v[142:143]
    v_pk_fma_f32 v[144:145], v[104:105], v[72:73], v[144:145]
    v_pk_fma_f32 v[146:147], v[106:107], v[70:71], v[146:147]
    v_pk_fma_f32 v[148:149], v[108:109], v[72:73], v[148:149]
    v_pk_fma_f32 v[150:151], v[110:111], v[70:71], v[150:151]
    v_pk_fma_f32 v[152:153], v[112:113], v[72:73], v[152:153]
    v_pk_fma_f32 v[122:123], v[86:87], v[66:67], v[122:123]
    v_pk_fma_f32 v[124:125], v[88:89], v[68:69], v[124:125]
    v_pk_fma_f32 v[126:127], v[90:91], v[66:67], v[126:127]
    v_pk_fma_f32 v[128:129], v[92:93], v[68:69], v[128:129]
    v_pk_fma_f32 v[130:131], v[94:95], v[66:67], v[130:131]
    v_pk_fma_f32 v[132:133], v[96:97], v[68:69], v[132:133]
    v_pk_fma_f32 v[134:135], v[98:99], v[66:67], v[134:135]
    v_pk_fma_f32 v[136:137], v[100:101], v[68:69], v[136:137]
    v_pk_fma_f32 v[138:139], v[102:103], v[66:67], v[138:139]
    v_pk_fma_f32 v[140:141], v[104:105], v[68:69], v[140:141]
    v_pk_fma_f32 v[142:143], v[106:107], v[66:67], v[142:143]
    v_pk_fma_f32 v[144:145], v[108:109], v[68:69], v[144:145]
    v_pk_fma_f32 v[146:147], v[110:111], v[66:67], v[146:147]
    v_pk_fma_f32 v[148:149], v[112:113], v[68:69], v[148:149]
    v_pk_fma_f32 v[150:151], v[114:115], v[66:67], v[150:151]
    v_pk_fma_f32 v[152:153], v[116:117], v[68:69], v[152:153]
    v_pk_fma_f32 v[122:123], v[90:91], v[62:63], v[122:123]
    v_pk_fma_f32 v[124:125], v[92:93], v[64:65], v[124:125]
    v_pk_fma_f32 v[126:127], v[94:95], v[62:63], v[126:127]
    v_pk_fma_f32 v[128:129], v[96:97], v[64:65], v[128:129]
    v_pk_fma_f32 v[130:131], v[98:99], v[62:63], v[130:131]
    v_pk_fma_f32 v[132:133], v[100:101], v[64:65], v[132:133]
    v_pk_fma_f32 v[134:135], v[102:103], v[62:63], v[134:135]
    v_pk_fma_f32 v[136:137], v[104:105], v[64:65], v[136:137]
    v_pk_fma_f32 v[138:139], v[106:107], v[62:63], v[138:139]
    v_pk_fma_f32 v[140:141], v[108:109], v[64:65], v[140:141]
    v_pk_fma_f32 v[142:143], v[110:111], v[62:63], v[142:143]
    v_pk_fma_f32 v[144:145], v[112:113], v[64:65], v[144:145]
    v_pk_fma_f32 v[146:147], v[114:115], v[62:63], v[146:147]
    v_pk_fma_f32 v[148:149], v[116:117], v[64:65], v[148:149]
    v_pk_fma_f32 v[150:151], v[118:119], v[62:63], v[150:151]
    v_pk_fma_f32 v[152:153], v[120:121], v[64:65], v[152:153]
    v_lshrrev_b32 v12, 2, v0
    v_mul_u32_u24 v12, 98304, v12
    v_and_b32 v13, 3, v0
    s_lshl_b32 s92, s2, 6
    v_lshl_add_u32 v13, v13, 4, s92
    v_add_u32 v12, v12, v13
    s_mov_b32 s4, 24576
    s_mov_b32 s5, 49152
    s_mov_b32 s6, 73728
    s_waitcnt vmcnt(0)
    v_lshlrev_b32 v154, 16, v38
    v_and_b32 v155, s93, v38
    v_pk_mul_f32 v[122:123], v[122:123], v[154:155]
    v_lshlrev_b32 v156, 16, v39
    v_and_b32 v157, s93, v39
    v_pk_mul_f32 v[124:125], v[124:125], v[156:157]
    v_lshlrev_b32 v154, 16, v40
    v_and_b32 v155, s93, v40
    v_pk_mul_f32 v[126:127], v[126:127], v[154:155]
    v_lshlrev_b32 v156, 16, v41
    v_and_b32 v157, s93, v41
    v_pk_mul_f32 v[128:129], v[128:129], v[156:157]
    v_lshlrev_b32 v154, 16, v42
    v_and_b32 v155, s93, v42
    v_pk_mul_f32 v[130:131], v[130:131], v[154:155]
    v_lshlrev_b32 v156, 16, v43
    v_and_b32 v157, s93, v43
    v_pk_mul_f32 v[132:133], v[132:133], v[156:157]
    v_lshlrev_b32 v154, 16, v44
    v_and_b32 v155, s93, v44
    v_pk_mul_f32 v[134:135], v[134:135], v[154:155]
    v_lshlrev_b32 v156, 16, v45
    v_and_b32 v157, s93, v45
    v_pk_mul_f32 v[136:137], v[136:137], v[156:157]
    v_lshlrev_b32 v154, 16, v46
    v_and_b32 v155, s93, v46
    v_pk_mul_f32 v[138:139], v[138:139], v[154:155]
    v_lshlrev_b32 v156, 16, v47
    v_and_b32 v157, s93, v47
    v_pk_mul_f32 v[140:141], v[140:141], v[156:157]
    v_lshlrev_b32 v154, 16, v48
    v_and_b32 v155, s93, v48
    v_pk_mul_f32 v[142:143], v[142:143], v[154:155]
    v_lshlrev_b32 v156, 16, v49
    v_and_b32 v157, s93, v49
    v_pk_mul_f32 v[144:145], v[144:145], v[156:157]
    v_lshlrev_b32 v154, 16, v50
    v_and_b32 v155, s93, v50
    v_pk_mul_f32 v[146:147], v[146:147], v[154:155]
    v_lshlrev_b32 v156, 16, v51
    v_and_b32 v157, s93, v51
    v_pk_mul_f32 v[148:149], v[148:149], v[156:157]
    v_lshlrev_b32 v154, 16, v52
    v_and_b32 v155, s93, v52
    v_pk_mul_f32 v[150:151], v[150:151], v[154:155]
    v_lshlrev_b32 v156, 16, v53
    v_and_b32 v157, s93, v53
    v_pk_mul_f32 v[152:153], v[152:153], v[156:157]
    v_cvt_pk_bf16_f32 v158, v150, v146
    v_cvt_pk_bf16_f32 v159, v142, v138
    v_cvt_pk_bf16_f32 v160, v134, v130
    v_cvt_pk_bf16_f32 v161, v126, v122
    v_cvt_pk_bf16_f32 v162, v151, v147
    v_cvt_pk_bf16_f32 v163, v143, v139
    v_cvt_pk_bf16_f32 v164, v135, v131
    v_cvt_pk_bf16_f32 v165, v127, v123
    v_cvt_pk_bf16_f32 v166, v152, v148
    v_cvt_pk_bf16_f32 v167, v144, v140
    v_cvt_pk_bf16_f32 v168, v136, v132
    v_cvt_pk_bf16_f32 v169, v128, v124
    v_cvt_pk_bf16_f32 v170, v153, v149
    v_cvt_pk_bf16_f32 v171, v145, v141
    v_cvt_pk_bf16_f32 v172, v137, v133
    v_cvt_pk_bf16_f32 v173, v129, v125
    buffer_store_dwordx4 v[158:161], v12, s[56:59], 0 offen sc1
    buffer_store_dwordx4 v[162:165], v12, s[56:59], s4 offen sc1
    buffer_store_dwordx4 v[166:169], v12, s[56:59], s5 offen sc1
    buffer_store_dwordx4 v[170:173], v12, s[56:59], s6 offen sc1
    v_dot2_u32_u16 v154, v158, s16, 0
    v_dot2_u32_u16 v155, v162, s16, 0
    v_dot2_u32_u16 v156, v166, s16, 0
    v_dot2_u32_u16 v157, v170, s16, 0
    v_dot2_u32_u16 v154, v159, s17, v154
    v_dot2_u32_u16 v155, v163, s17, v155
    v_dot2_u32_u16 v156, v167, s17, v156
    v_dot2_u32_u16 v157, v171, s17, v157
    v_dot2_u32_u16 v154, v160, s18, v154
    v_dot2_u32_u16 v155, v164, s18, v155
    v_dot2_u32_u16 v156, v168, s18, v156
    v_dot2_u32_u16 v157, v172, s18, v157
    v_dot2_u32_u16 v154, v161, s19, v154
    v_dot2_u32_u16 v155, v165, s19, v155
    v_dot2_u32_u16 v156, v169, s19, v156
    v_dot2_u32_u16 v157, v173, s19, v157
    v_add_u32_dpp v154, v154, v154 quad_perm:[1,0,3,2] row_mask:0xf bank_mask:0xf
    v_add_u32_dpp v155, v155, v155 quad_perm:[1,0,3,2] row_mask:0xf bank_mask:0xf
    v_add_u32_dpp v156, v156, v156 quad_perm:[1,0,3,2] row_mask:0xf bank_mask:0xf
    v_add_u32_dpp v157, v157, v157 quad_perm:[1,0,3,2] row_mask:0xf bank_mask:0xf
    v_add_u32_dpp v154, v154, v154 quad_perm:[2,3,0,1] row_mask:0xf bank_mask:0xf
    v_add_u32_dpp v155, v155, v155 quad_perm:[2,3,0,1] row_mask:0xf bank_mask:0xf
    v_add_u32_dpp v156, v156, v156 quad_perm:[2,3,0,1] row_mask:0xf bank_mask:0xf
    v_add_u32_dpp v157, v157, v157 quad_perm:[2,3,0,1] row_mask:0xf bank_mask:0xf
    v_cndmask_b32 v154, v154, v155, s[8:9]
    v_cndmask_b32 v156, v156, v157, s[8:9]
    v_lshlrev_b32 v13, 2, v0
    s_lshl_b32 s92, s2, 10
    s_add_u32 s92, s92, 6361088
    v_cndmask_b32 v154, v154, v156, s[10:11]
    s_add_u32 s13, s13, 1
    v_add3_u32 v154, v154, v174, 1
    buffer_store_dword v154, v13, s[56:59], s92 offen sc1
    buffer_load_dwordx4 v[178:181], v10, s[44:47], 0 offen offset:0
    buffer_load_dwordx2 v[176:177], v9, s[44:47], 0 offen
    buffer_load_dwordx4 v[184:187], v10, s[44:47], 0 offen offset:1024
    buffer_load_dwordx2 v[182:183], v11, s[44:47], 0 offen offset:0
    buffer_load_dwordx4 v[190:193], v10, s[44:47], 0 offen offset:2048
    buffer_load_dwordx2 v[188:189], v11, s[44:47], 0 offen offset:1024
    buffer_load_dwordx4 v[196:199], v10, s[44:47], 0 offen offset:3072
    buffer_load_dwordx2 v[194:195], v11, s[44:47], 0 offen offset:2048
    buffer_load_ushort v175, v8, s[48:51], 0 offen
    v_lshlrev_b32 v10, 4, v0
    v_add_u32 v10, 154752, v10
    ds_write2_b32 v10, v158, v162 offset0:0 offset1:1
    ds_write2_b32 v10, v166, v170 offset0:2 offset1:3
    v_lshl_add_u32 v10, v1, 4, s98
    s_waitcnt vmcnt(0)
    ds_write_b128 v10, v[178:181] offset:32
    v_alignbit_b32 v16, v178, v177, 16
    v_mov_b32 v20, v177
    v_alignbit_b32 v24, v177, v176, 16
    v_alignbit_b32 v17, v179, v178, 16
    v_mov_b32 v21, v178
    v_alignbit_b32 v25, v178, v177, 16
    v_alignbit_b32 v18, v180, v179, 16
    v_mov_b32 v22, v179
    v_alignbit_b32 v26, v179, v178, 16
    v_alignbit_b32 v19, v181, v180, 16
    v_mov_b32 v23, v180
    v_alignbit_b32 v27, v180, v179, 16
    ds_write_b128 v10, v[16:19] offset:4192
    ds_write_b128 v10, v[20:23] offset:8352
    ds_write_b128 v10, v[24:27] offset:12512
    ds_write_b128 v10, v[184:187] offset:1056
    v_alignbit_b32 v28, v184, v183, 16
    v_mov_b32 v32, v183
    v_alignbit_b32 v36, v183, v182, 16
    v_alignbit_b32 v29, v185, v184, 16
    v_mov_b32 v33, v184
    v_alignbit_b32 v37, v184, v183, 16
    v_alignbit_b32 v30, v186, v185, 16
    v_mov_b32 v34, v185
    v_alignbit_b32 v38, v185, v184, 16
    v_alignbit_b32 v31, v187, v186, 16
    v_mov_b32 v35, v186
    v_alignbit_b32 v39, v186, v185, 16
    ds_write_b128 v10, v[28:31] offset:5216
    ds_write_b128 v10, v[32:35] offset:9376
    ds_write_b128 v10, v[36:39] offset:13536
    ds_write_b128 v10, v[190:193] offset:2080
    v_alignbit_b32 v40, v190, v189, 16
    v_mov_b32 v44, v189
    v_alignbit_b32 v48, v189, v188, 16
    v_alignbit_b32 v41, v191, v190, 16
    v_mov_b32 v45, v190
    v_alignbit_b32 v49, v190, v189, 16
    v_alignbit_b32 v42, v192, v191, 16
    v_mov_b32 v46, v191
    v_alignbit_b32 v50, v191, v190, 16
    v_alignbit_b32 v43, v193, v192, 16
    v_mov_b32 v47, v192
    v_alignbit_b32 v51, v192, v191, 16
    ds_write_b128 v10, v[40:43] offset:6240
    ds_write_b128 v10, v[44:47] offset:10400
    ds_write_b128 v10, v[48:51] offset:14560
    ds_write_b128 v10, v[196:199] offset:3104
    v_alignbit_b32 v52, v196, v195, 16
    v_mov_b32 v56, v195
    v_alignbit_b32 v60, v195, v194, 16
    v_alignbit_b32 v53, v197, v196, 16
    v_mov_b32 v57, v196
    v_alignbit_b32 v61, v196, v195, 16
    v_alignbit_b32 v54, v198, v197, 16
    v_mov_b32 v58, v197
    v_alignbit_b32 v62, v197, v196, 16
    v_alignbit_b32 v55, v199, v198, 16
    v_mov_b32 v59, v198
    v_alignbit_b32 v63, v198, v197, 16
    ds_write_b128 v10, v[52:55] offset:7264
    ds_write_b128 v10, v[56:59] offset:11424
    ds_write_b128 v10, v[60:63] offset:15584
    v_and_b32 v8, 15, v1
    v_lshrrev_b32 v9, 4, v1
    v_lshl_add_u32 v11, v9, 3, v8
    v_sub_u32 v11, 15, v11
    v_and_b32 v13, 1, v11
    v_lshlrev_b32 v13, 4, v13
    v_lshlrev_b32 v175, v13, v175
    v_ashrrev_i32 v11, 1, v11
    v_cmp_eq_u32 vcc, 0, v11
    s_nop 1
    v_cndmask_b32 v208, 0, v175, vcc
    v_cmp_eq_u32 vcc, 1, v11
    s_nop 1
    v_cndmask_b32 v209, 0, v175, vcc
    v_cmp_eq_u32 vcc, 2, v11
    s_nop 1
    v_cndmask_b32 v210, 0, v175, vcc
    v_cmp_eq_u32 vcc, 3, v11
    s_nop 1
    v_cndmask_b32 v211, 0, v175, vcc
    v_sub_u32 v11, 3, v8
    v_and_b32 v11, 3, v11
    v_add3_u32 v13, v8, v11, 1
    v_lshl_add_u32 v13, v9, 3, v13
    v_mul_u32_u24 v11, 4160, v11
    v_lshl_add_u32 v14, v13, 1, v11
    v_add_u32 v14, s98, v14
    v_lshlrev_b32 v15, 1, v8
    v_sub_u32 v15, v15, v9
    v_add_u32 v15, 25, v15
    v_lshl_add_u32 v15, v15, 4, s99
    v_and_b32 v11, 3, v0
    v_mul_u32_u24 v11, 4640, v11
    v_lshrrev_b32 v13, 2, v0
    v_lshl_add_u32 v11, v13, 4, v11
    v_add_u32 v11, 66560, v11
    v_lshlrev_b32 v13, 4, v13
    s_waitcnt lgkmcnt(0)
    ds_read_b64 v[16:17], v14 offset:0
    ds_read_b64 v[18:19], v14 offset:8
    ds_read_b64 v[20:21], v14 offset:512
    ds_read_b64 v[22:23], v14 offset:520
    ds_read_b64 v[24:25], v14 offset:1024
    ds_read_b64 v[26:27], v14 offset:1032
    ds_read_b64 v[28:29], v14 offset:1536
    ds_read_b64 v[30:31], v14 offset:1544
    ds_read_b64 v[32:33], v14 offset:2048
    ds_read_b64 v[34:35], v14 offset:2056
    ds_read_b64 v[36:37], v14 offset:2560
    ds_read_b64 v[38:39], v14 offset:2568
    ds_read_b64 v[40:41], v14 offset:3072
    ds_read_b64 v[42:43], v14 offset:3080
    ds_read_b64 v[44:45], v14 offset:3584
    ds_read_b64 v[46:47], v14 offset:3592
    v_and_b32 v12, 3, v0
    v_lshlrev_b32 v13, 6, v13
    v_lshl_add_u32 v13, v12, 16, v13
    s_lshl2_add_u32 s7, s2, 6361088
    s_mov_b32 s14, 0x11111111
    s_mov_b32 s15, s14
    s_mov_b32 s91, 0x40000
L1:
    ds_read_b32 v4, v2 offset:0
    s_sub_u32 s91, s91, 1
    s_cbranch_scc1 L2
    s_waitcnt lgkmcnt(0)
    v_readfirstlane_b32 s92, v4
    s_cmp_lt_u32 s92, 4
    s_cbranch_scc1 L1
L2:
    s_mov_b32 s91, 8192
    buffer_load_dwordx4 v[80:83], v7, s[56:59], 0 offen sc1
    buffer_load_dwordx4 v[84:87], v7, s[56:59], s88 offen sc1
    buffer_load_dwordx4 v[88:91], v7, s[56:59], s89 offen sc1
    buffer_load_dwordx4 v[92:95], v7, s[56:59], s90 offen sc1
    buffer_load_dword v96, v13, s[56:59], s7 offen sc1
    s_branch L4
L3:
    s_mov_b64 exec, s[20:21]
    s_cbranch_execz L6
    buffer_load_dwordx4 v[80:83], v7, s[56:59], 0 offen sc1
L6:
    s_mov_b64 exec, s[22:23]
    s_cbranch_execz L7
    buffer_load_dwordx4 v[84:87], v7, s[56:59], s88 offen sc1
L7:
    s_mov_b64 exec, s[24:25]
    s_cbranch_execz L8
    buffer_load_dwordx4 v[88:91], v7, s[56:59], s89 offen sc1
L8:
    s_mov_b64 exec, s[26:27]
    s_cbranch_execz L9
    buffer_load_dwordx4 v[92:95], v7, s[56:59], s90 offen sc1
L9:
    s_mov_b64 exec, s[28:29]
    s_cbranch_execz L10
    buffer_load_dword v96, v13, s[56:59], s7 offen sc1
L10:
    s_mov_b64 exec, -1
L4:
    s_sub_u32 s91, s91, 1
    s_waitcnt vmcnt(0)
    s_cbranch_scc1 L5
    v_dot2_u32_u16 v100, v80, s16, 0
    v_dot2_u32_u16 v101, v84, s16, 0
    v_dot2_u32_u16 v102, v88, s16, 0
    v_dot2_u32_u16 v103, v92, s16, 0
    v_dot2_u32_u16 v100, v81, s17, v100
    v_dot2_u32_u16 v101, v85, s17, v101
    v_dot2_u32_u16 v102, v89, s17, v102
    v_dot2_u32_u16 v103, v93, s17, v103
    v_dot2_u32_u16 v100, v82, s18, v100
    v_dot2_u32_u16 v101, v86, s18, v101
    v_dot2_u32_u16 v102, v90, s18, v102
    v_dot2_u32_u16 v103, v94, s18, v103
    v_dot2_u32_u16 v100, v83, s19, v100
    v_dot2_u32_u16 v101, v87, s19, v101
    v_dot2_u32_u16 v102, v91, s19, v102
    v_dot2_u32_u16 v103, v95, s19, v103
    v_add_u32_dpp v100, v100, v100 quad_perm:[1,0,3,2] row_mask:0xf bank_mask:0xf
    v_add_u32_dpp v101, v101, v101 quad_perm:[1,0,3,2] row_mask:0xf bank_mask:0xf
    v_add_u32_dpp v102, v102, v102 quad_perm:[1,0,3,2] row_mask:0xf bank_mask:0xf
    v_add_u32_dpp v103, v103, v103 quad_perm:[1,0,3,2] row_mask:0xf bank_mask:0xf
    v_add_u32_dpp v100, v100, v100 quad_perm:[2,3,0,1] row_mask:0xf bank_mask:0xf
    v_add_u32_dpp v101, v101, v101 quad_perm:[2,3,0,1] row_mask:0xf bank_mask:0xf
    v_add_u32_dpp v102, v102, v102 quad_perm:[2,3,0,1] row_mask:0xf bank_mask:0xf
    v_add_u32_dpp v103, v103, v103 quad_perm:[2,3,0,1] row_mask:0xf bank_mask:0xf
    v_cndmask_b32 v100, v100, v101, s[8:9]
    v_cndmask_b32 v102, v102, v103, s[8:9]
    v_cndmask_b32 v100, v100, v102, s[10:11]
    v_sub_u32 v4, v96, v100
    v_cmp_ne_u32 s[28:29], s13, v4
    s_lshr_b64 s[20:21], s[28:29], 0
    s_and_b64 s[20:21], s[20:21], s[14:15]
    s_wqm_b64 s[20:21], s[20:21]
    s_lshr_b64 s[22:23], s[28:29], 1
    s_and_b64 s[22:23], s[22:23], s[14:15]
    s_wqm_b64 s[22:23], s[22:23]
    s_lshr_b64 s[24:25], s[28:29], 2
    s_and_b64 s[24:25], s[24:25], s[14:15]
    s_wqm_b64 s[24:25], s[24:25]
    s_lshr_b64 s[26:27], s[28:29], 3
    s_and_b64 s[26:27], s[26:27], s[14:15]
    s_wqm_b64 s[26:27], s[26:27]
    s_cmp_lg_u64 s[28:29], 0
    s_cbranch_scc1 L3
L5:
    ds_write_b128 v11, v[80:83] offset:512
    ds_write_b128 v11, v[84:87] offset:1536
    ds_write_b128 v11, v[88:91] offset:2560
    ds_write_b128 v11, v[92:95] offset:3584
    s_mov_b64 exec, 1
    ds_add_u32 v2, v3 offset:4
    s_mov_b64 exec, -1
    v_mov_b32 v212, v80
    v_mov_b32 v213, v84
    v_mov_b32 v214, v88
    v_mov_b32 v215, v92
    s_lshl_b32 s92, s97, 15
    v_lshl_add_u32 v12, v0, 3, s92
    v_add_u32 v13, 0x4000, v12
    s_mov_b32 s91, 0x40000
L11:
    ds_read_b32 v4, v2 offset:4
    s_sub_u32 s91, s91, 1
    s_cbranch_scc1 L12
    s_waitcnt lgkmcnt(0)
    v_readfirstlane_b32 s92, v4
    s_cmp_lt_u32 s92, 4
    s_cbranch_scc1 L11
L12:
    ds_read_b128 v[48:51], v15 offset:128
    ds_read_b128 v[52:55], v15 offset:640
    ds_read_b128 v[56:59], v15 offset:1152
    ds_read_b128 v[60:63], v15 offset:1664
    ds_read_b128 v[64:67], v15 offset:2176
    ds_read_b128 v[68:71], v15 offset:2688
    ds_read_b128 v[72:75], v15 offset:3200
    ds_read_b128 v[76:79], v15 offset:3712
    s_mov_b32 s91, 4
    s_setprio 2
    s_waitcnt lgkmcnt(0)
    v_mfma_f32_16x16x32_bf16 v[144:147], v[208:211], v[48:51], 0
    v_mfma_f32_16x16x32_bf16 v[148:151], v[208:211], v[52:55], 0
    v_mfma_f32_16x16x32_bf16 v[152:155], v[208:211], v[56:59], 0
    v_mfma_f32_16x16x32_bf16 v[156:159], v[208:211], v[60:63], 0
    v_mfma_f32_16x16x32_bf16 v[160:163], v[208:211], v[64:67], 0
    v_mfma_f32_16x16x32_bf16 v[164:167], v[208:211], v[68:71], 0
    v_mfma_f32_16x16x32_bf16 v[168:171], v[208:211], v[72:75], 0
    v_mfma_f32_16x16x32_bf16 v[172:175], v[208:211], v[76:79], 0
L_conv:
    s_cmp_lg_u32 s91, 2
    s_cbranch_scc1 L13
    s_cmp_ge_u32 s0, 224
    s_cbranch_scc1 L13
    buffer_load_dwordx2 v[176:177], v12, s[52:55], 0 offen nt
    buffer_load_dwordx2 v[178:179], v12, s[52:55], 0 offen offset:2048 nt
    buffer_load_dwordx2 v[180:181], v12, s[52:55], s88 offen nt
    buffer_load_dwordx2 v[182:183], v12, s[52:55], s88 offen offset:2048 nt
    buffer_load_dwordx2 v[184:185], v12, s[52:55], s89 offen nt
    buffer_load_dwordx2 v[186:187], v12, s[52:55], s89 offen offset:2048 nt
    buffer_load_dwordx2 v[188:189], v12, s[52:55], s90 offen nt
    buffer_load_dwordx2 v[190:191], v12, s[52:55], s90 offen offset:2048 nt
    buffer_load_dwordx2 v[192:193], v13, s[52:55], 0 offen nt
    buffer_load_dwordx2 v[194:195], v13, s[52:55], 0 offen offset:2048 nt
    buffer_load_dwordx2 v[196:197], v13, s[52:55], s88 offen nt
    buffer_load_dwordx2 v[198:199], v13, s[52:55], s88 offen offset:2048 nt
    buffer_load_dwordx2 v[200:201], v13, s[52:55], s89 offen nt
    buffer_load_dwordx2 v[202:203], v13, s[52:55], s89 offen offset:2048 nt
    buffer_load_dwordx2 v[204:205], v13, s[52:55], s90 offen nt
    buffer_load_dwordx2 v[206:207], v13, s[52:55], s90 offen offset:2048 nt
L13:
    v_mfma_f32_16x16x32_bf16 v[144:147], v[16:19], v[48:51], v[144:147]
    ds_read_b128 v[112:115], v15 offset:64
    v_mfma_f32_16x16x32_bf16 v[148:151], v[16:19], v[52:55], v[148:151]
    ds_read_b128 v[116:119], v15 offset:576
    v_mfma_f32_16x16x32_bf16 v[152:155], v[16:19], v[56:59], v[152:155]
    ds_read_b128 v[120:123], v15 offset:1088
    v_mfma_f32_16x16x32_bf16 v[156:159], v[16:19], v[60:63], v[156:159]
    ds_read_b128 v[124:127], v15 offset:1600
    v_mfma_f32_16x16x32_bf16 v[160:163], v[16:19], v[64:67], v[160:163]
    ds_read_b128 v[128:131], v15 offset:2112
    v_mfma_f32_16x16x32_bf16 v[164:167], v[16:19], v[68:71], v[164:167]
    ds_read_b128 v[132:135], v15 offset:2624
    v_mfma_f32_16x16x32_bf16 v[168:171], v[16:19], v[72:75], v[168:171]
    ds_read_b128 v[136:139], v15 offset:3136
    v_mfma_f32_16x16x32_bf16 v[172:175], v[16:19], v[76:79], v[172:175]
    ds_read_b128 v[140:143], v15 offset:3648
    v_mfma_f32_16x16x32_bf16 v[148:151], v[20:23], v[48:51], v[148:151]
    ds_read_b64 v[80:81], v14 offset:64
    v_mfma_f32_16x16x32_bf16 v[152:155], v[20:23], v[52:55], v[152:155]
    ds_read_b64 v[82:83], v14 offset:72
    v_mfma_f32_16x16x32_bf16 v[156:159], v[20:23], v[56:59], v[156:159]
    ds_read_b64 v[84:85], v14 offset:576
    v_mfma_f32_16x16x32_bf16 v[160:163], v[20:23], v[60:63], v[160:163]
    ds_read_b64 v[86:87], v14 offset:584
    v_mfma_f32_16x16x32_bf16 v[164:167], v[20:23], v[64:67], v[164:167]
    ds_read_b64 v[88:89], v14 offset:1088
    v_mfma_f32_16x16x32_bf16 v[168:171], v[20:23], v[68:71], v[168:171]
    ds_read_b64 v[90:91], v14 offset:1096
    v_mfma_f32_16x16x32_bf16 v[172:175], v[20:23], v[72:75], v[172:175]
    ds_read_b64 v[92:93], v14 offset:1600
    v_mfma_f32_16x16x32_bf16 v[152:155], v[24:27], v[48:51], v[152:155]
    ds_read_b64 v[94:95], v14 offset:1608
    v_mfma_f32_16x16x32_bf16 v[156:159], v[24:27], v[52:55], v[156:159]
    ds_read_b64 v[96:97], v14 offset:2112
    v_mfma_f32_16x16x32_bf16 v[160:163], v[24:27], v[56:59], v[160:163]
    ds_read_b64 v[98:99], v14 offset:2120
    v_mfma_f32_16x16x32_bf16 v[164:167], v[24:27], v[60:63], v[164:167]
    ds_read_b64 v[100:101], v14 offset:2624
    v_mfma_f32_16x16x32_bf16 v[168:171], v[24:27], v[64:67], v[168:171]
    ds_read_b64 v[102:103], v14 offset:2632
    v_mfma_f32_16x16x32_bf16 v[172:175], v[24:27], v[68:71], v[172:175]
    ds_read_b64 v[104:105], v14 offset:3136
    v_mfma_f32_16x16x32_bf16 v[156:159], v[28:31], v[48:51], v[156:159]
    ds_read_b64 v[106:107], v14 offset:3144
    v_mfma_f32_16x16x32_bf16 v[160:163], v[28:31], v[52:55], v[160:163]
    ds_read_b64 v[108:109], v14 offset:3648
    v_mfma_f32_16x16x32_bf16 v[164:167], v[28:31], v[56:59], v[164:167]
    ds_read_b64 v[110:111], v14 offset:3656
    v_mfma_f32_16x16x32_bf16 v[168:171], v[28:31], v[60:63], v[168:171]
    v_mfma_f32_16x16x32_bf16 v[172:175], v[28:31], v[64:67], v[172:175]
    v_mfma_f32_16x16x32_bf16 v[160:163], v[32:35], v[48:51], v[160:163]
    v_mfma_f32_16x16x32_bf16 v[164:167], v[32:35], v[52:55], v[164:167]
    v_mfma_f32_16x16x32_bf16 v[168:171], v[32:35], v[56:59], v[168:171]
    v_mfma_f32_16x16x32_bf16 v[172:175], v[32:35], v[60:63], v[172:175]
    v_mfma_f32_16x16x32_bf16 v[164:167], v[36:39], v[48:51], v[164:167]
    v_mfma_f32_16x16x32_bf16 v[168:171], v[36:39], v[52:55], v[168:171]
    v_mfma_f32_16x16x32_bf16 v[172:175], v[36:39], v[56:59], v[172:175]
    v_mfma_f32_16x16x32_bf16 v[168:171], v[40:43], v[48:51], v[168:171]
    v_mfma_f32_16x16x32_bf16 v[172:175], v[40:43], v[52:55], v[172:175]
    v_mfma_f32_16x16x32_bf16 v[172:175], v[44:47], v[48:51], v[172:175]
    s_waitcnt lgkmcnt(0)
    v_mfma_f32_16x16x32_bf16 v[144:147], v[80:83], v[112:115], v[144:147]
    ds_read_b128 v[48:51], v15 offset:0
    v_mfma_f32_16x16x32_bf16 v[148:151], v[80:83], v[116:119], v[148:151]
    ds_read_b128 v[52:55], v15 offset:512
    v_mfma_f32_16x16x32_bf16 v[152:155], v[80:83], v[120:123], v[152:155]
    ds_read_b128 v[56:59], v15 offset:1024
    v_mfma_f32_16x16x32_bf16 v[156:159], v[80:83], v[124:127], v[156:159]
    ds_read_b128 v[60:63], v15 offset:1536
    v_mfma_f32_16x16x32_bf16 v[160:163], v[80:83], v[128:131], v[160:163]
    ds_read_b128 v[64:67], v15 offset:2048
    v_mfma_f32_16x16x32_bf16 v[164:167], v[80:83], v[132:135], v[164:167]
    ds_read_b128 v[68:71], v15 offset:2560
    v_mfma_f32_16x16x32_bf16 v[168:171], v[80:83], v[136:139], v[168:171]
    ds_read_b128 v[72:75], v15 offset:3072
    v_mfma_f32_16x16x32_bf16 v[172:175], v[80:83], v[140:143], v[172:175]
    ds_read_b128 v[76:79], v15 offset:3584
    v_mfma_f32_16x16x32_bf16 v[148:151], v[84:87], v[112:115], v[148:151]
    ds_read_b64 v[16:17], v14 offset:128
    v_mfma_f32_16x16x32_bf16 v[152:155], v[84:87], v[116:119], v[152:155]
    ds_read_b64 v[18:19], v14 offset:136
    v_mfma_f32_16x16x32_bf16 v[156:159], v[84:87], v[120:123], v[156:159]
    ds_read_b64 v[20:21], v14 offset:640
    v_mfma_f32_16x16x32_bf16 v[160:163], v[84:87], v[124:127], v[160:163]
    ds_read_b64 v[22:23], v14 offset:648
    v_mfma_f32_16x16x32_bf16 v[164:167], v[84:87], v[128:131], v[164:167]
    ds_read_b64 v[24:25], v14 offset:1152
    v_mfma_f32_16x16x32_bf16 v[168:171], v[84:87], v[132:135], v[168:171]
    ds_read_b64 v[26:27], v14 offset:1160
    v_mfma_f32_16x16x32_bf16 v[172:175], v[84:87], v[136:139], v[172:175]
    ds_read_b64 v[28:29], v14 offset:1664
    v_mfma_f32_16x16x32_bf16 v[152:155], v[88:91], v[112:115], v[152:155]
    ds_read_b64 v[30:31], v14 offset:1672
    v_mfma_f32_16x16x32_bf16 v[156:159], v[88:91], v[116:119], v[156:159]
    ds_read_b64 v[32:33], v14 offset:2176
    v_mfma_f32_16x16x32_bf16 v[160:163], v[88:91], v[120:123], v[160:163]
    ds_read_b64 v[34:35], v14 offset:2184
    v_mfma_f32_16x16x32_bf16 v[164:167], v[88:91], v[124:127], v[164:167]
    ds_read_b64 v[36:37], v14 offset:2688
    v_mfma_f32_16x16x32_bf16 v[168:171], v[88:91], v[128:131], v[168:171]
    ds_read_b64 v[38:39], v14 offset:2696
    v_mfma_f32_16x16x32_bf16 v[172:175], v[88:91], v[132:135], v[172:175]
    ds_read_b64 v[40:41], v14 offset:3200
    v_mfma_f32_16x16x32_bf16 v[156:159], v[92:95], v[112:115], v[156:159]
    ds_read_b64 v[42:43], v14 offset:3208
    v_mfma_f32_16x16x32_bf16 v[160:163], v[92:95], v[116:119], v[160:163]
    ds_read_b64 v[44:45], v14 offset:3712
    v_mfma_f32_16x16x32_bf16 v[164:167], v[92:95], v[120:123], v[164:167]
    ds_read_b64 v[46:47], v14 offset:3720
    v_mfma_f32_16x16x32_bf16 v[168:171], v[92:95], v[124:127], v[168:171]
    v_mfma_f32_16x16x32_bf16 v[172:175], v[92:95], v[128:131], v[172:175]
    v_mfma_f32_16x16x32_bf16 v[160:163], v[96:99], v[112:115], v[160:163]
    v_mfma_f32_16x16x32_bf16 v[164:167], v[96:99], v[116:119], v[164:167]
    v_mfma_f32_16x16x32_bf16 v[168:171], v[96:99], v[120:123], v[168:171]
    v_mfma_f32_16x16x32_bf16 v[172:175], v[96:99], v[124:127], v[172:175]
    v_mfma_f32_16x16x32_bf16 v[164:167], v[100:103], v[112:115], v[164:167]
    v_mfma_f32_16x16x32_bf16 v[168:171], v[100:103], v[116:119], v[168:171]
    v_mfma_f32_16x16x32_bf16 v[172:175], v[100:103], v[120:123], v[172:175]
    v_mfma_f32_16x16x32_bf16 v[168:171], v[104:107], v[112:115], v[168:171]
    v_mfma_f32_16x16x32_bf16 v[172:175], v[104:107], v[116:119], v[172:175]
    v_mfma_f32_16x16x32_bf16 v[172:175], v[108:111], v[112:115], v[172:175]
    v_add_u32 v14, 128, v14
    v_add_u32 v15, -128, v15
    s_sub_u32 s91, s91, 1
    s_cmp_lg_u32 s91, 0
    s_waitcnt lgkmcnt(0)
    s_cbranch_scc1 L_conv
    s_setprio 0
    s_lshl_b32 s92, s3, 6
    s_add_u32 s92, s92, s98
    v_lshlrev_b32 v10, 5, v8
    v_lshl_add_u32 v10, v9, 3, v10
    v_add_u32 v10, s92, v10
    v_and_b32 v11, 3, v0
    v_lshrrev_b32 v14, 2, v0
    v_mul_u32_u24 v11, 16704, v11
    v_lshl_add_u32 v11, v14, 4, v11
    v_cvt_pk_bf16_f32 v16, v144, v145
    v_cvt_pk_bf16_f32 v17, v146, v147
    ds_write_b64 v10, v[16:17] offset:0
    v_cvt_pk_bf16_f32 v18, v148, v149
    v_cvt_pk_bf16_f32 v19, v150, v151
    ds_write_b64 v10, v[18:19] offset:512
    v_cvt_pk_bf16_f32 v20, v152, v153
    v_cvt_pk_bf16_f32 v21, v154, v155
    ds_write_b64 v10, v[20:21] offset:1024
    v_cvt_pk_bf16_f32 v22, v156, v157
    v_cvt_pk_bf16_f32 v23, v158, v159
    ds_write_b64 v10, v[22:23] offset:1536
    v_cvt_pk_bf16_f32 v24, v160, v161
    v_cvt_pk_bf16_f32 v25, v162, v163
    ds_write_b64 v10, v[24:25] offset:2048
    v_cvt_pk_bf16_f32 v26, v164, v165
    v_cvt_pk_bf16_f32 v27, v166, v167
    ds_write_b64 v10, v[26:27] offset:2560
    v_cvt_pk_bf16_f32 v28, v168, v169
    v_cvt_pk_bf16_f32 v29, v170, v171
    ds_write_b64 v10, v[28:29] offset:3072
    v_cvt_pk_bf16_f32 v30, v172, v173
    v_cvt_pk_bf16_f32 v31, v174, v175
    ds_write_b64 v10, v[30:31] offset:3584
    s_mov_b64 exec, 1
    ds_add_u32 v2, v3 offset:8
    s_mov_b64 exec, -1
    s_mov_b32 s91, 0x40000
L14:
    ds_read_b32 v4, v2 offset:8
    s_sub_u32 s91, s91, 1
    s_cbranch_scc1 L15
    s_waitcnt lgkmcnt(0)
    v_readfirstlane_b32 s92, v4
    s_cmp_lt_u32 s92, 4
    s_cbranch_scc1 L14
L15:
    ds_read_b128 v[32:35], v11 offset:0
    ds_read_b128 v[36:39], v11 offset:1024
    ds_read_b128 v[40:43], v11 offset:2048
    ds_read_b128 v[44:47], v11 offset:3072
    s_waitcnt lgkmcnt(0)
    v_cmp_eq_u32 vcc, v32, v212
    s_nop 1
    v_addc_co_u32 v32, vcc, 0, v32, vcc
    buffer_store_dwordx4 v[32:35], v7, s[56:59], 0 offen sc1
    v_cmp_eq_u32 vcc, v36, v213
    s_nop 1
    v_addc_co_u32 v36, vcc, 0, v36, vcc
    buffer_store_dwordx4 v[36:39], v7, s[56:59], s88 offen sc1
    v_cmp_eq_u32 vcc, v40, v214
    s_nop 1
    v_addc_co_u32 v40, vcc, 0, v40, vcc
    buffer_store_dwordx4 v[40:43], v7, s[56:59], s89 offen sc1
    v_cmp_eq_u32 vcc, v44, v215
    s_nop 1
    v_addc_co_u32 v44, vcc, 0, v44, vcc
    buffer_store_dwordx4 v[44:47], v7, s[56:59], s90 offen sc1
    s_cmp_ge_u32 s0, 224
    s_cbranch_scc1 L_nodown
    s_waitcnt vmcnt(4)
    v_lshlrev_b32 v48, 16, v176
    v_and_b32 v49, s93, v176
    v_lshlrev_b32 v50, 16, v177
    v_and_b32 v51, s93, v177
    v_lshlrev_b32 v52, 16, v178
    v_and_b32 v53, s93, v178
    v_lshlrev_b32 v54, 16, v179
    v_and_b32 v55, s93, v179
    v_lshlrev_b32 v56, 16, v180
    v_and_b32 v57, s93, v180
    v_lshlrev_b32 v58, 16, v181
    v_and_b32 v59, s93, v181
    v_lshlrev_b32 v60, 16, v182
    v_and_b32 v61, s93, v182
    v_lshlrev_b32 v62, 16, v183
    v_and_b32 v63, s93, v183
    v_lshlrev_b32 v64, 16, v184
    v_and_b32 v65, s93, v184
    v_lshlrev_b32 v66, 16, v185
    v_and_b32 v67, s93, v185
    v_lshlrev_b32 v68, 16, v186
    v_and_b32 v69, s93, v186
    v_lshlrev_b32 v70, 16, v187
    v_and_b32 v71, s93, v187
    v_lshlrev_b32 v72, 16, v188
    v_and_b32 v73, s93, v188
    v_lshlrev_b32 v74, 16, v189
    v_and_b32 v75, s93, v189
    v_lshlrev_b32 v76, 16, v190
    v_and_b32 v77, s93, v190
    v_lshlrev_b32 v78, 16, v191
    v_and_b32 v79, s93, v191
    v_lshlrev_b32 v80, 16, v192
    v_and_b32 v81, s93, v192
    v_lshlrev_b32 v82, 16, v193
    v_and_b32 v83, s93, v193
    v_lshlrev_b32 v84, 16, v194
    v_and_b32 v85, s93, v194
    v_lshlrev_b32 v86, 16, v195
    v_and_b32 v87, s93, v195
    v_lshlrev_b32 v88, 16, v196
    v_and_b32 v89, s93, v196
    v_lshlrev_b32 v90, 16, v197
    v_and_b32 v91, s93, v197
    v_lshlrev_b32 v92, 16, v198
    v_and_b32 v93, s93, v198
    v_lshlrev_b32 v94, 16, v199
    v_and_b32 v95, s93, v199
    v_lshlrev_b32 v96, 16, v200
    v_and_b32 v97, s93, v200
    v_lshlrev_b32 v98, 16, v201
    v_and_b32 v99, s93, v201
    v_lshlrev_b32 v100, 16, v202
    v_and_b32 v101, s93, v202
    v_lshlrev_b32 v102, 16, v203
    v_and_b32 v103, s93, v203
    v_lshlrev_b32 v104, 16, v204
    v_and_b32 v105, s93, v204
    v_lshlrev_b32 v106, 16, v205
    v_and_b32 v107, s93, v205
    v_lshlrev_b32 v108, 16, v206
    v_and_b32 v109, s93, v206
    v_lshlrev_b32 v110, 16, v207
    v_and_b32 v111, s93, v207
    v_lshlrev_b32 v10, 4, v8
    s_mul_i32 s12, s0, 24576
    s_add_u32 s12, s12, 23552
    v_lshlrev_b32 v13, 3, v8
    s_lshl_b32 s92, s3, 7
    s_add_u32 s92, s92, 160032
    v_add_u32 v13, s92, v13
    v_mov_b32 v14, s92
    v_lshrrev_b32 v12, 2, v0
    v_mul_u32_u24 v12, 98304, v12
    v_and_b32 v11, 1, v0
    v_mul_u32_u24 v11, 24576, v11
    v_add_u32 v12, v12, v11
    v_and_b32 v11, 2, v0
    v_lshl_add_u32 v12, v11, 3, v12
    s_lshl_b32 s4, s97, 5
    s_add_u32 s4, s4, 16384
    s_add_u32 s5, s4, 24576
    s_add_u32 s6, s4, 49152
    s_add_u32 s7, s4, 73728
    s_mov_b32 s91, 0x40000
L16:
    ds_read_b32 v4, v2 offset:20
    s_sub_u32 s91, s91, 1
    s_cbranch_scc1 L17
    s_waitcnt lgkmcnt(0)
    v_readfirstlane_b32 s92, v4
    s_cmp_lt_u32 s92, 4
    s_cbranch_scc1 L16
L17:
    v_mov_b32 v14, 160032
    s_mov_b32 s91, 0x40000
L18:
    ds_read_b32 v4, v2 offset:24
    s_sub_u32 s91, s91, 1
    s_cbranch_scc1 L19
    s_waitcnt lgkmcnt(0)
    v_readfirstlane_b32 s92, v4
    s_cmp_lt_u32 s92, 1
    s_cbranch_scc1 L18
L19:
    ds_read_b128 v[112:115], v14 offset:0
    ds_read_b128 v[116:119], v14 offset:16
    ds_read_b128 v[120:123], v14 offset:32
    ds_read_b128 v[124:127], v14 offset:48
    ds_read_b128 v[128:131], v14 offset:64
    ds_read_b128 v[132:135], v14 offset:80
    ds_read_b128 v[136:139], v14 offset:96
    ds_read_b128 v[140:143], v14 offset:112
    s_waitcnt lgkmcnt(0)
    v_pk_mul_f32 v[16:17], v[112:113], v[48:49] op_sel:[0,0] op_sel_hi:[1,0]
    v_pk_mul_f32 v[18:19], v[112:113], v[48:49] op_sel:[0,1] op_sel_hi:[1,1]
    v_pk_mul_f32 v[20:21], v[112:113], v[50:51] op_sel:[0,0] op_sel_hi:[1,0]
    v_pk_mul_f32 v[22:23], v[112:113], v[50:51] op_sel:[0,1] op_sel_hi:[1,1]
    v_pk_fma_f32 v[16:17], v[114:115], v[52:53], v[16:17] op_sel:[0,0,0] op_sel_hi:[1,0,1]
    v_pk_fma_f32 v[18:19], v[114:115], v[52:53], v[18:19] op_sel:[0,1,0] op_sel_hi:[1,1,1]
    v_pk_fma_f32 v[20:21], v[114:115], v[54:55], v[20:21] op_sel:[0,0,0] op_sel_hi:[1,0,1]
    v_pk_fma_f32 v[22:23], v[114:115], v[54:55], v[22:23] op_sel:[0,1,0] op_sel_hi:[1,1,1]
    v_pk_fma_f32 v[16:17], v[116:117], v[56:57], v[16:17] op_sel:[0,0,0] op_sel_hi:[1,0,1]
    v_pk_fma_f32 v[18:19], v[116:117], v[56:57], v[18:19] op_sel:[0,1,0] op_sel_hi:[1,1,1]
    v_pk_fma_f32 v[20:21], v[116:117], v[58:59], v[20:21] op_sel:[0,0,0] op_sel_hi:[1,0,1]
    v_pk_fma_f32 v[22:23], v[116:117], v[58:59], v[22:23] op_sel:[0,1,0] op_sel_hi:[1,1,1]
    v_pk_fma_f32 v[16:17], v[118:119], v[60:61], v[16:17] op_sel:[0,0,0] op_sel_hi:[1,0,1]
    v_pk_fma_f32 v[18:19], v[118:119], v[60:61], v[18:19] op_sel:[0,1,0] op_sel_hi:[1,1,1]
    v_pk_fma_f32 v[20:21], v[118:119], v[62:63], v[20:21] op_sel:[0,0,0] op_sel_hi:[1,0,1]
    v_pk_fma_f32 v[22:23], v[118:119], v[62:63], v[22:23] op_sel:[0,1,0] op_sel_hi:[1,1,1]
    v_pk_fma_f32 v[16:17], v[120:121], v[64:65], v[16:17] op_sel:[0,0,0] op_sel_hi:[1,0,1]
    v_pk_fma_f32 v[18:19], v[120:121], v[64:65], v[18:19] op_sel:[0,1,0] op_sel_hi:[1,1,1]
    v_pk_fma_f32 v[20:21], v[120:121], v[66:67], v[20:21] op_sel:[0,0,0] op_sel_hi:[1,0,1]
    v_pk_fma_f32 v[22:23], v[120:121], v[66:67], v[22:23] op_sel:[0,1,0] op_sel_hi:[1,1,1]
    v_pk_fma_f32 v[16:17], v[122:123], v[68:69], v[16:17] op_sel:[0,0,0] op_sel_hi:[1,0,1]
    v_pk_fma_f32 v[18:19], v[122:123], v[68:69], v[18:19] op_sel:[0,1,0] op_sel_hi:[1,1,1]
    v_pk_fma_f32 v[20:21], v[122:123], v[70:71], v[20:21] op_sel:[0,0,0] op_sel_hi:[1,0,1]
    v_pk_fma_f32 v[22:23], v[122:123], v[70:71], v[22:23] op_sel:[0,1,0] op_sel_hi:[1,1,1]
    v_pk_fma_f32 v[16:17], v[124:125], v[72:73], v[16:17] op_sel:[0,0,0] op_sel_hi:[1,0,1]
    v_pk_fma_f32 v[18:19], v[124:125], v[72:73], v[18:19] op_sel:[0,1,0] op_sel_hi:[1,1,1]
    v_pk_fma_f32 v[20:21], v[124:125], v[74:75], v[20:21] op_sel:[0,0,0] op_sel_hi:[1,0,1]
    v_pk_fma_f32 v[22:23], v[124:125], v[74:75], v[22:23] op_sel:[0,1,0] op_sel_hi:[1,1,1]
    v_pk_fma_f32 v[16:17], v[126:127], v[76:77], v[16:17] op_sel:[0,0,0] op_sel_hi:[1,0,1]
    v_pk_fma_f32 v[18:19], v[126:127], v[76:77], v[18:19] op_sel:[0,1,0] op_sel_hi:[1,1,1]
    v_pk_fma_f32 v[20:21], v[126:127], v[78:79], v[20:21] op_sel:[0,0,0] op_sel_hi:[1,0,1]
    v_pk_fma_f32 v[22:23], v[126:127], v[78:79], v[22:23] op_sel:[0,1,0] op_sel_hi:[1,1,1]
    v_pk_fma_f32 v[16:17], v[128:129], v[80:81], v[16:17] op_sel:[0,0,0] op_sel_hi:[1,0,1]
    v_pk_fma_f32 v[18:19], v[128:129], v[80:81], v[18:19] op_sel:[0,1,0] op_sel_hi:[1,1,1]
    v_pk_fma_f32 v[20:21], v[128:129], v[82:83], v[20:21] op_sel:[0,0,0] op_sel_hi:[1,0,1]
    v_pk_fma_f32 v[22:23], v[128:129], v[82:83], v[22:23] op_sel:[0,1,0] op_sel_hi:[1,1,1]
    v_pk_fma_f32 v[16:17], v[130:131], v[84:85], v[16:17] op_sel:[0,0,0] op_sel_hi:[1,0,1]
    v_pk_fma_f32 v[18:19], v[130:131], v[84:85], v[18:19] op_sel:[0,1,0] op_sel_hi:[1,1,1]
    v_pk_fma_f32 v[20:21], v[130:131], v[86:87], v[20:21] op_sel:[0,0,0] op_sel_hi:[1,0,1]
    v_pk_fma_f32 v[22:23], v[130:131], v[86:87], v[22:23] op_sel:[0,1,0] op_sel_hi:[1,1,1]
    v_pk_fma_f32 v[16:17], v[132:133], v[88:89], v[16:17] op_sel:[0,0,0] op_sel_hi:[1,0,1]
    v_pk_fma_f32 v[18:19], v[132:133], v[88:89], v[18:19] op_sel:[0,1,0] op_sel_hi:[1,1,1]
    v_pk_fma_f32 v[20:21], v[132:133], v[90:91], v[20:21] op_sel:[0,0,0] op_sel_hi:[1,0,1]
    v_pk_fma_f32 v[22:23], v[132:133], v[90:91], v[22:23] op_sel:[0,1,0] op_sel_hi:[1,1,1]
    v_pk_fma_f32 v[16:17], v[134:135], v[92:93], v[16:17] op_sel:[0,0,0] op_sel_hi:[1,0,1]
    v_pk_fma_f32 v[18:19], v[134:135], v[92:93], v[18:19] op_sel:[0,1,0] op_sel_hi:[1,1,1]
    v_pk_fma_f32 v[20:21], v[134:135], v[94:95], v[20:21] op_sel:[0,0,0] op_sel_hi:[1,0,1]
    v_pk_fma_f32 v[22:23], v[134:135], v[94:95], v[22:23] op_sel:[0,1,0] op_sel_hi:[1,1,1]
    v_pk_fma_f32 v[16:17], v[136:137], v[96:97], v[16:17] op_sel:[0,0,0] op_sel_hi:[1,0,1]
    v_pk_fma_f32 v[18:19], v[136:137], v[96:97], v[18:19] op_sel:[0,1,0] op_sel_hi:[1,1,1]
    v_pk_fma_f32 v[20:21], v[136:137], v[98:99], v[20:21] op_sel:[0,0,0] op_sel_hi:[1,0,1]
    v_pk_fma_f32 v[22:23], v[136:137], v[98:99], v[22:23] op_sel:[0,1,0] op_sel_hi:[1,1,1]
    v_pk_fma_f32 v[16:17], v[138:139], v[100:101], v[16:17] op_sel:[0,0,0] op_sel_hi:[1,0,1]
    v_pk_fma_f32 v[18:19], v[138:139], v[100:101], v[18:19] op_sel:[0,1,0] op_sel_hi:[1,1,1]
    v_pk_fma_f32 v[20:21], v[138:139], v[102:103], v[20:21] op_sel:[0,0,0] op_sel_hi:[1,0,1]
    v_pk_fma_f32 v[22:23], v[138:139], v[102:103], v[22:23] op_sel:[0,1,0] op_sel_hi:[1,1,1]
    v_pk_fma_f32 v[16:17], v[140:141], v[104:105], v[16:17] op_sel:[0,0,0] op_sel_hi:[1,0,1]
    v_pk_fma_f32 v[18:19], v[140:141], v[104:105], v[18:19] op_sel:[0,1,0] op_sel_hi:[1,1,1]
    v_pk_fma_f32 v[20:21], v[140:141], v[106:107], v[20:21] op_sel:[0,0,0] op_sel_hi:[1,0,1]
    v_pk_fma_f32 v[22:23], v[140:141], v[106:107], v[22:23] op_sel:[0,1,0] op_sel_hi:[1,1,1]
    v_pk_fma_f32 v[16:17], v[142:143], v[108:109], v[16:17] op_sel:[0,0,0] op_sel_hi:[1,0,1]
    v_pk_fma_f32 v[18:19], v[142:143], v[108:109], v[18:19] op_sel:[0,1,0] op_sel_hi:[1,1,1]
    v_pk_fma_f32 v[20:21], v[142:143], v[110:111], v[20:21] op_sel:[0,0,0] op_sel_hi:[1,0,1]
    v_pk_fma_f32 v[22:23], v[142:143], v[110:111], v[22:23] op_sel:[0,1,0] op_sel_hi:[1,1,1]
    s_mov_b32 vcc_lo, 0x55555555
    s_mov_b32 vcc_hi, 0x55555555
    v_cndmask_b32_dpp v24, v18, v16, vcc quad_perm:[1,0,3,2] row_mask:0xf bank_mask:0xf
    v_cndmask_b32_dpp v25, v19, v17, vcc quad_perm:[1,0,3,2] row_mask:0xf bank_mask:0xf
    v_cndmask_b32_dpp v28, v22, v20, vcc quad_perm:[1,0,3,2] row_mask:0xf bank_mask:0xf
    v_cndmask_b32_dpp v29, v23, v21, vcc quad_perm:[1,0,3,2] row_mask:0xf bank_mask:0xf
    s_not_b64 vcc, vcc
    v_cndmask_b32_dpp v26, v16, v18, vcc quad_perm:[1,0,3,2] row_mask:0xf bank_mask:0xf
    v_cndmask_b32_dpp v27, v17, v19, vcc quad_perm:[1,0,3,2] row_mask:0xf bank_mask:0xf
    v_cndmask_b32_dpp v30, v20, v22, vcc quad_perm:[1,0,3,2] row_mask:0xf bank_mask:0xf
    v_cndmask_b32_dpp v31, v21, v23, vcc quad_perm:[1,0,3,2] row_mask:0xf bank_mask:0xf
    buffer_store_dwordx4 v[24:27], v12, s[56:59], s4 offen sc1
    buffer_store_dwordx4 v[28:31], v12, s[56:59], s6 offen sc1
L_nodown:
    s_barrier
    s_cmp_lg_u32 s3, 0
    s_cbranch_scc1 L_end
    s_mov_b32 s91, 0x40000
L20:
    ds_read_b32 v4, v2 offset:16
    s_sub_u32 s91, s91, 1
    s_cbranch_scc1 L21
    s_waitcnt lgkmcnt(0)
    v_readfirstlane_b32 s92, v4
    s_cmp_lt_u32 s92, 4
    s_cbranch_scc1 L20
L21:
    v_mov_b32 v28, s13
    s_lshl2_add_u32 s92, s2, 6356992
    s_mov_b64 exec, 1
    buffer_store_dword v28, off, s[56:59], s92 sc1
    s_mov_b64 exec, -1
    v_and_b32 v10, 1, v1
    v_bfe_u32 v11, v1, 1, 2
    v_lshlrev_b32 v12, 2, v10
    v_add_u32 v12, 158944, v12
    ds_read_b32 v24, v12
    v_lshl_add_u32 v12, v11, 2, s100
    v_lshlrev_b32 v12, 1, v12
    v_lshlrev_b32 v13, 3, v10
    v_add_u32 v13, 158848, v13
    ds_read_b64 v[30:31], v13
    v_mul_u32_u24 v11, 16704, v11
    s_waitcnt lgkmcnt(0)
    v_and_b32 v14, 0x7ff, v24
    v_sub_u32 v14, 0x7ff, v14
    v_lshl_add_u32 v11, v14, 1, v11
    ds_read_u16 v27, v11
    v_lshl_add_u32 v12, v14, 11, v12
    buffer_load_ushort v26, v12, s[76:79], 0 offen
    v_ashrrev_i32 v14, 31, v24
    v_not_b32 v14, v14
    v_or_b32 v14, 0x80000000, v14
    v_xor_b32 v24, v24, v14
    v_and_b32 v24, s93, v24
    v_mul_f32 v24, 0xbfb8aa3b, v24
    v_exp_f32 v24, v24
    s_nop 0
    v_add_f32 v24, 1.0, v24
    v_rcp_f32 v24, v24
    s_nop 0
    v_cvt_pk_bf16_f32 v24, v24, v24
    v_lshlrev_b32 v24, 16, v24
    s_waitcnt vmcnt(0)
    v_lshlrev_b32 v26, 16, v26
    v_sub_f32 v25, v26, v30
    v_cvt_pk_bf16_f32 v25, v25, v25
    v_lshlrev_b32 v25, 16, v25
    v_mul_f32 v25, v31, v25
    v_cvt_pk_bf16_f32 v25, v25, v25
    v_lshlrev_b32 v25, 16, v25
    s_waitcnt lgkmcnt(0)
    v_lshlrev_b32 v27, 16, v27
    v_mul_f32 v27, v25, v27
    v_add_u32 v7, 16384, v7
    v_lshlrev_b32 v10, 4, v10
    v_lshl_add_u32 v10, v9, 5, v10
    v_add_u32 v10, 160544, v10
    v_and_b32 v11, 7, v1
    v_lshlrev_b32 v11, 2, v11
    v_add_u32 v11, 160544, v11
    v_cvt_pk_bf16_f32 v27, v27, v27
    v_lshlrev_b32 v27, 16, v27
    s_mov_b32 s91, 0x40000
L22:
    ds_read_b32 v4, v2 offset:12
    s_sub_u32 s91, s91, 1
    s_cbranch_scc1 L23
    s_waitcnt lgkmcnt(0)
    v_readfirstlane_b32 s92, v4
    s_cmp_lt_u32 s92, 8
    s_cbranch_scc1 L22
L23:
    s_mov_b32 s91, 8192
    buffer_load_dwordx4 v[32:35], v7, s[56:59], 0 offen offset:0 sc1
    buffer_load_dwordx4 v[36:39], v7, s[56:59], 0 offen offset:1024 sc1
    buffer_load_dwordx4 v[40:43], v7, s[56:59], 0 offen offset:2048 sc1
    buffer_load_dwordx4 v[44:47], v7, s[56:59], 0 offen offset:3072 sc1
    buffer_load_dwordx4 v[48:51], v7, s[56:59], s88 offen offset:0 sc1
    buffer_load_dwordx4 v[52:55], v7, s[56:59], s88 offen offset:1024 sc1
    buffer_load_dwordx4 v[56:59], v7, s[56:59], s88 offen offset:2048 sc1
    s_branch L25
L24:
    s_mov_b64 exec, s[20:21]
    s_cbranch_execz L27
    buffer_load_dwordx4 v[32:35], v7, s[56:59], 0 offen offset:0 sc1
L27:
    s_mov_b64 exec, s[22:23]
    s_cbranch_execz L28
    buffer_load_dwordx4 v[36:39], v7, s[56:59], 0 offen offset:1024 sc1
L28:
    s_mov_b64 exec, s[24:25]
    s_cbranch_execz L29
    buffer_load_dwordx4 v[40:43], v7, s[56:59], 0 offen offset:2048 sc1
L29:
    s_mov_b64 exec, s[26:27]
    s_cbranch_execz L30
    buffer_load_dwordx4 v[44:47], v7, s[56:59], 0 offen offset:3072 sc1
L30:
    s_mov_b64 exec, s[28:29]
    s_cbranch_execz L31
    buffer_load_dwordx4 v[48:51], v7, s[56:59], s88 offen offset:0 sc1
L31:
    s_mov_b64 exec, s[30:31]
    s_cbranch_execz L32
    buffer_load_dwordx4 v[52:55], v7, s[56:59], s88 offen offset:1024 sc1
L32:
    s_mov_b64 exec, s[8:9]
    s_cbranch_execz L33
    buffer_load_dwordx4 v[56:59], v7, s[56:59], s88 offen offset:2048 sc1
L33:
    s_mov_b64 exec, -1
L25:
    s_sub_u32 s91, s91, 1
    s_waitcnt vmcnt(0)
    s_cbranch_scc1 L26
    v_max_u32 v60, v32, v33
    v_max3_u32 v60, v60, v34, v35
    v_max_u32 v61, v36, v37
    v_max3_u32 v61, v61, v38, v39
    v_max_u32 v62, v40, v41
    v_max3_u32 v62, v62, v42, v43
    v_max_u32 v63, v44, v45
    v_max3_u32 v63, v63, v46, v47
    v_max_u32 v64, v48, v49
    v_max3_u32 v64, v64, v50, v51
    v_max_u32 v65, v52, v53
    v_max3_u32 v65, v65, v54, v55
    v_max_u32 v66, v56, v57
    v_max3_u32 v66, v66, v58, v59
    v_cmp_eq_u32 s[20:21], -1, v60
    v_cmp_eq_u32 s[22:23], -1, v61
    v_cmp_eq_u32 s[24:25], -1, v62
    v_cmp_eq_u32 s[26:27], -1, v63
    v_cmp_eq_u32 s[28:29], -1, v64
    v_cmp_eq_u32 s[30:31], -1, v65
    v_cmp_eq_u32 s[8:9], -1, v66
    s_or_b64 vcc, s[20:21], s[22:23]
    s_or_b64 vcc, vcc, s[24:25]
    s_or_b64 vcc, vcc, s[26:27]
    s_or_b64 vcc, vcc, s[28:29]
    s_or_b64 vcc, vcc, s[30:31]
    s_or_b64 vcc, vcc, s[8:9]
    s_cbranch_scc1 L24
L26:
    v_pk_add_f32 v[32:33], v[32:33], v[36:37]
    v_pk_add_f32 v[34:35], v[34:35], v[38:39]
    v_pk_add_f32 v[32:33], v[32:33], v[40:41]
    v_pk_add_f32 v[34:35], v[34:35], v[42:43]
    v_pk_add_f32 v[32:33], v[32:33], v[44:45]
    v_pk_add_f32 v[34:35], v[34:35], v[46:47]
    v_pk_add_f32 v[32:33], v[32:33], v[48:49]
    v_pk_add_f32 v[34:35], v[34:35], v[50:51]
    v_pk_add_f32 v[32:33], v[32:33], v[52:53]
    v_pk_add_f32 v[34:35], v[34:35], v[54:55]
    v_pk_add_f32 v[32:33], v[32:33], v[56:57]
    v_pk_add_f32 v[34:35], v[34:35], v[58:59]
    s_nop 0
    v_add_f32_dpp v32, v32, v32 row_ror:2 row_mask:0xf bank_mask:0xf
    v_add_f32_dpp v33, v33, v33 row_ror:2 row_mask:0xf bank_mask:0xf
    v_add_f32_dpp v34, v34, v34 row_ror:2 row_mask:0xf bank_mask:0xf
    v_add_f32_dpp v35, v35, v35 row_ror:2 row_mask:0xf bank_mask:0xf
    v_add_f32_dpp v32, v32, v32 row_ror:4 row_mask:0xf bank_mask:0xf
    v_add_f32_dpp v33, v33, v33 row_ror:4 row_mask:0xf bank_mask:0xf
    v_add_f32_dpp v34, v34, v34 row_ror:4 row_mask:0xf bank_mask:0xf
    v_add_f32_dpp v35, v35, v35 row_ror:4 row_mask:0xf bank_mask:0xf
    v_add_f32_dpp v32, v32, v32 row_ror:8 row_mask:0xf bank_mask:0xf
    v_add_f32_dpp v33, v33, v33 row_ror:8 row_mask:0xf bank_mask:0xf
    v_add_f32_dpp v34, v34, v34 row_ror:8 row_mask:0xf bank_mask:0xf
    v_add_f32_dpp v35, v35, v35 row_ror:8 row_mask:0xf bank_mask:0xf
    ds_write_b128 v10, v[32:35]
    ds_read2_b32 v[36:37], v11 offset0:0 offset1:8
    ds_read2_b32 v[38:39], v11 offset0:16 offset1:24
    s_waitcnt lgkmcnt(0)
    v_pk_add_f32 v[36:37], v[36:37], v[38:39]
    v_add_f32 v36, v36, v37
    v_cvt_pk_bf16_f32 v36, v36, v36
    v_lshlrev_b32 v36, 16, v36
    v_mul_f32 v36, v36, v24
    v_cvt_pk_bf16_f32 v36, v36, v36
    v_lshlrev_b32 v36, 16, v36
    v_add_f32 v36, v36, v25
    v_cvt_pk_bf16_f32 v36, v36, v36
    v_lshlrev_b32 v36, 16, v36
    v_mul_f32 v37, 0xbfb8aa3b, v36
    v_exp_f32 v37, v37
    s_nop 0
    v_add_f32 v37, 1.0, v37
    v_rcp_f32 v37, v37
    s_nop 0
    v_mul_f32 v36, v36, v37
    v_cvt_pk_bf16_f32 v36, v36, v36
    v_lshlrev_b32 v36, 16, v36
    v_mul_f32 v36, v36, v27
    v_cvt_pk_bf16_f32 v36, v36, v36
    v_lshlrev_b32 v36, 16, v36
    v_add_f32 v36, v36, v26
    v_cvt_pk_bf16_f32 v36, v36, v36
    s_mov_b64 exec, 0xff
    buffer_store_short v36, v12, s[84:87], 0 offen
    s_branch L_fin
L_aux:
    s_cmp_ge_u32 s3, 6
    s_cbranch_scc1 L34
    v_add_u32 v8, 16384, v7
    buffer_store_dwordx4 v[12:15], v8, s[56:59], 0 offen sc1
    buffer_store_dwordx4 v[12:15], v8, s[56:59], 0 offen offset:2048 sc1
    buffer_store_dwordx4 v[12:15], v8, s[56:59], s88 offen sc1
    buffer_store_dwordx4 v[12:15], v8, s[56:59], s88 offen offset:2048 sc1
L34:
    buffer_load_dword v71, v5, s[56:59], s99 offen
    v_lshlrev_b32 v69, 2, v0
    buffer_load_dword v70, v69, s[56:59], s99 offen
    s_mov_b32 s32, s4
    s_and_b32 s33, s5, 0xffff
    s_mov_b32 s34, 4194304
    s_mov_b32 s35, 0x00020000
    s_mov_b32 s36, s18
    s_and_b32 s37, s19, 0xffff
    s_mov_b32 s38, 2048
    s_mov_b32 s39, 0x00020000
    s_and_b32 s98, s3, 3
    s_lshl_b32 s92, s98, 12
    s_add_u32 s92, s92, s95
    v_lshlrev_b32 v11, 4, v1
    v_add_u32 v9, s92, v11
    buffer_load_dwordx4 v[16:19], v9, s[32:35], 0 offen offset:0
    buffer_load_dwordx4 v[20:23], v9, s[32:35], 0 offen offset:1024
    buffer_load_dwordx4 v[24:27], v9, s[32:35], 0 offen offset:2048
    buffer_load_dwordx4 v[28:31], v9, s[32:35], 0 offen offset:3072
    buffer_load_dwordx4 v[32:35], v11, s[36:39], 0 offen offset:0
    buffer_load_dwordx4 v[36:39], v11, s[36:39], 0 offen offset:1024
    s_mov_b32 s80, s28
    s_and_b32 s81, s29, 0xffff
    s_mov_b32 s82, 256
    s_mov_b32 s83, 0x00020000
    s_mov_b32 s84, s26
    s_and_b32 s85, s27, 0xffff
    s_mov_b32 s86, 4194304
    s_mov_b32 s87, 0x00020000
    s_mov_b32 s40, s20
    s_and_b32 s41, s21, 0xffff
    s_mov_b32 s42, 7340032
    s_mov_b32 s43, 0x00020000
    s_mov_b32 s44, s22
    s_and_b32 s45, s23, 0xffff
    s_mov_b32 s46, 7340032
    s_mov_b32 s47, 0x00020000
    s_mov_b32 s52, s24
    s_and_b32 s53, s25, 0xffff
    s_mov_b32 s54, 7340032
    s_mov_b32 s55, 0x00020000
    s_waitcnt vmcnt(0)
    s_mul_i32 s92, s98, 4640
    s_add_u32 s92, s92, 67072
    v_add_u32 v8, s92, v11
    s_lshl_b32 s92, s98, 12
    s_add_u32 s92, s92, 101504
    v_add_u32 v9, s92, v11
    ds_write_b128 v8, v[16:19] offset:0
    ds_write_b128 v8, v[20:23] offset:1024
    ds_write_b128 v8, v[24:27] offset:2048
    ds_write_b128 v8, v[28:31] offset:3072
    v_mov_b32 v56, 0
    v_mov_b32 v57, 0
    v_mov_b32 v58, 0
    v_mov_b32 v59, 0
    v_dot2_f32_bf16 v56, v16, s94, v56
    v_dot2_f32_bf16 v57, v16, v16, v57
    v_dot2_f32_bf16 v58, v24, s94, v58
    v_dot2_f32_bf16 v59, v24, v24, v59
    v_dot2_f32_bf16 v56, v17, s94, v56
    v_dot2_f32_bf16 v57, v17, v17, v57
    v_dot2_f32_bf16 v58, v25, s94, v58
    v_dot2_f32_bf16 v59, v25, v25, v59
    v_dot2_f32_bf16 v56, v18, s94, v56
    v_dot2_f32_bf16 v57, v18, v18, v57
    v_dot2_f32_bf16 v58, v26, s94, v58
    v_dot2_f32_bf16 v59, v26, v26, v59
    v_dot2_f32_bf16 v56, v19, s94, v56
    v_dot2_f32_bf16 v57, v19, v19, v57
    v_dot2_f32_bf16 v58, v27, s94, v58
    v_dot2_f32_bf16 v59, v27, v27, v59
    v_dot2_f32_bf16 v56, v20, s94, v56
    v_dot2_f32_bf16 v57, v20, v20, v57
    v_dot2_f32_bf16 v58, v28, s94, v58
    v_dot2_f32_bf16 v59, v28, v28, v59
    v_dot2_f32_bf16 v56, v21, s94, v56
    v_dot2_f32_bf16 v57, v21, v21, v57
    v_dot2_f32_bf16 v58, v29, s94, v58
    v_dot2_f32_bf16 v59, v29, v29, v59
    v_dot2_f32_bf16 v56, v22, s94, v56
    v_dot2_f32_bf16 v57, v22, v22, v57
    v_dot2_f32_bf16 v58, v30, s94, v58
    v_dot2_f32_bf16 v59, v30, v30, v59
    v_dot2_f32_bf16 v56, v23, s94, v56
    v_dot2_f32_bf16 v57, v23, v23, v57
    v_dot2_f32_bf16 v58, v31, s94, v58
    v_dot2_f32_bf16 v59, v31, v31, v59
    v_add_f32_dpp v56, v56, v56 row_ror:1 row_mask:0xf bank_mask:0xf
    v_add_f32_dpp v57, v57, v57 row_ror:1 row_mask:0xf bank_mask:0xf
    v_add_f32_dpp v58, v58, v58 row_ror:1 row_mask:0xf bank_mask:0xf
    v_add_f32_dpp v59, v59, v59 row_ror:1 row_mask:0xf bank_mask:0xf
    v_add_f32_dpp v56, v56, v56 row_ror:2 row_mask:0xf bank_mask:0xf
    v_add_f32_dpp v57, v57, v57 row_ror:2 row_mask:0xf bank_mask:0xf
    v_add_f32_dpp v58, v58, v58 row_ror:2 row_mask:0xf bank_mask:0xf
    v_add_f32_dpp v59, v59, v59 row_ror:2 row_mask:0xf bank_mask:0xf
    v_add_f32_dpp v56, v56, v56 row_ror:4 row_mask:0xf bank_mask:0xf
    v_add_f32_dpp v57, v57, v57 row_ror:4 row_mask:0xf bank_mask:0xf
    v_add_f32_dpp v58, v58, v58 row_ror:4 row_mask:0xf bank_mask:0xf
    v_add_f32_dpp v59, v59, v59 row_ror:4 row_mask:0xf bank_mask:0xf
    v_add_f32_dpp v56, v56, v56 row_ror:8 row_mask:0xf bank_mask:0xf
    v_add_f32_dpp v57, v57, v57 row_ror:8 row_mask:0xf bank_mask:0xf
    v_add_f32_dpp v58, v58, v58 row_ror:8 row_mask:0xf bank_mask:0xf
    v_add_f32_dpp v59, v59, v59 row_ror:8 row_mask:0xf bank_mask:0xf
    v_add_f32_dpp v56, v56, v56 row_bcast:15 row_mask:0xa bank_mask:0xf
    v_add_f32_dpp v57, v57, v57 row_bcast:15 row_mask:0xa bank_mask:0xf
    v_add_f32_dpp v58, v58, v58 row_bcast:15 row_mask:0xa bank_mask:0xf
    v_add_f32_dpp v59, v59, v59 row_bcast:15 row_mask:0xa bank_mask:0xf
    v_add_f32_dpp v56, v56, v56 row_bcast:31 row_mask:0xc bank_mask:0xf
    v_add_f32_dpp v57, v57, v57 row_bcast:31 row_mask:0xc bank_mask:0xf
    v_add_f32_dpp v58, v58, v58 row_bcast:31 row_mask:0xc bank_mask:0xf
    v_add_f32_dpp v59, v59, v59 row_bcast:31 row_mask:0xc bank_mask:0xf
    v_mul_f32 v56, 0x3a800000, v56
    v_mul_f32 v57, 0x3a800000, v57
    v_fma_f32 v57, -v56, v56, v57
    v_max_f32 v57, 0, v57
    v_cvt_pk_bf16_f32 v57, v57, v57
    v_lshlrev_b32 v57, 16, v57
    v_add_f32 v57, 0x3727c5ac, v57
    v_cvt_pk_bf16_f32 v57, v57, v57
    v_lshlrev_b32 v57, 16, v57
    v_sqrt_f32 v57, v57
    v_cvt_pk_bf16_f32 v56, v56, v56
    v_lshlrev_b32 v56, 16, v56
    v_cvt_pk_bf16_f32 v57, v57, v57
    v_lshlrev_b32 v57, 16, v57
    v_rcp_f32 v57, v57
    v_readlane_b32 s4, v56, 63
    s_nop 3
    v_readlane_b32 s5, v57, 63
    v_mul_f32 v58, 0x3a800000, v58
    v_mul_f32 v59, 0x3a800000, v59
    v_fma_f32 v59, -v58, v58, v59
    v_max_f32 v59, 0, v59
    v_cvt_pk_bf16_f32 v59, v59, v59
    v_lshlrev_b32 v59, 16, v59
    v_add_f32 v59, 0x3727c5ac, v59
    v_cvt_pk_bf16_f32 v59, v59, v59
    v_lshlrev_b32 v59, 16, v59
    v_sqrt_f32 v59, v59
    v_cvt_pk_bf16_f32 v58, v58, v58
    v_lshlrev_b32 v58, 16, v58
    v_cvt_pk_bf16_f32 v59, v59, v59
    v_lshlrev_b32 v59, 16, v59
    v_rcp_f32 v59, v59
    v_readlane_b32 s6, v58, 63
    s_nop 3
    v_readlane_b32 s7, v59, 63
    v_lshlrev_b32 v60, 16, v16
    v_and_b32 v61, s93, v16
    v_subrev_f32 v60, s4, v60
    v_subrev_f32 v61, s4, v61
    v_cvt_pk_bf16_f32 v61, v60, v61
    v_lshlrev_b32 v60, 16, v61
    v_and_b32 v61, s93, v61
    v_mul_f32 v60, s5, v60
    v_mul_f32 v61, s5, v61
    v_cvt_pk_bf16_f32 v16, v60, v61
    v_lshlrev_b32 v62, 16, v17
    v_and_b32 v63, s93, v17
    v_subrev_f32 v62, s4, v62
    v_subrev_f32 v63, s4, v63
    v_cvt_pk_bf16_f32 v63, v62, v63
    v_lshlrev_b32 v62, 16, v63
    v_and_b32 v63, s93, v63
    v_mul_f32 v62, s5, v62
    v_mul_f32 v63, s5, v63
    v_cvt_pk_bf16_f32 v17, v62, v63
    v_lshlrev_b32 v64, 16, v18
    v_and_b32 v65, s93, v18
    v_subrev_f32 v64, s4, v64
    v_subrev_f32 v65, s4, v65
    v_cvt_pk_bf16_f32 v65, v64, v65
    v_lshlrev_b32 v64, 16, v65
    v_and_b32 v65, s93, v65
    v_mul_f32 v64, s5, v64
    v_mul_f32 v65, s5, v65
    v_cvt_pk_bf16_f32 v18, v64, v65
    v_lshlrev_b32 v66, 16, v19
    v_and_b32 v67, s93, v19
    v_subrev_f32 v66, s4, v66
    v_subrev_f32 v67, s4, v67
    v_cvt_pk_bf16_f32 v67, v66, v67
    v_lshlrev_b32 v66, 16, v67
    v_and_b32 v67, s93, v67
    v_mul_f32 v66, s5, v66
    v_mul_f32 v67, s5, v67
    v_cvt_pk_bf16_f32 v19, v66, v67
    v_lshlrev_b32 v60, 16, v20
    v_and_b32 v61, s93, v20
    v_subrev_f32 v60, s4, v60
    v_subrev_f32 v61, s4, v61
    v_cvt_pk_bf16_f32 v61, v60, v61
    v_lshlrev_b32 v60, 16, v61
    v_and_b32 v61, s93, v61
    v_mul_f32 v60, s5, v60
    v_mul_f32 v61, s5, v61
    v_cvt_pk_bf16_f32 v20, v60, v61
    v_lshlrev_b32 v62, 16, v21
    v_and_b32 v63, s93, v21
    v_subrev_f32 v62, s4, v62
    v_subrev_f32 v63, s4, v63
    v_cvt_pk_bf16_f32 v63, v62, v63
    v_lshlrev_b32 v62, 16, v63
    v_and_b32 v63, s93, v63
    v_mul_f32 v62, s5, v62
    v_mul_f32 v63, s5, v63
    v_cvt_pk_bf16_f32 v21, v62, v63
    v_lshlrev_b32 v64, 16, v22
    v_and_b32 v65, s93, v22
    v_subrev_f32 v64, s4, v64
    v_subrev_f32 v65, s4, v65
    v_cvt_pk_bf16_f32 v65, v64, v65
    v_lshlrev_b32 v64, 16, v65
    v_and_b32 v65, s93, v65
    v_mul_f32 v64, s5, v64
    v_mul_f32 v65, s5, v65
    v_cvt_pk_bf16_f32 v22, v64, v65
    v_lshlrev_b32 v66, 16, v23
    v_and_b32 v67, s93, v23
    v_subrev_f32 v66, s4, v66
    v_subrev_f32 v67, s4, v67
    v_cvt_pk_bf16_f32 v67, v66, v67
    v_lshlrev_b32 v66, 16, v67
    v_and_b32 v67, s93, v67
    v_mul_f32 v66, s5, v66
    v_mul_f32 v67, s5, v67
    v_cvt_pk_bf16_f32 v23, v66, v67
    v_lshlrev_b32 v60, 16, v24
    v_and_b32 v61, s93, v24
    v_subrev_f32 v60, s6, v60
    v_subrev_f32 v61, s6, v61
    v_cvt_pk_bf16_f32 v61, v60, v61
    v_lshlrev_b32 v60, 16, v61
    v_and_b32 v61, s93, v61
    v_mul_f32 v60, s7, v60
    v_mul_f32 v61, s7, v61
    v_cvt_pk_bf16_f32 v24, v60, v61
    v_lshlrev_b32 v62, 16, v25
    v_and_b32 v63, s93, v25
    v_subrev_f32 v62, s6, v62
    v_subrev_f32 v63, s6, v63
    v_cvt_pk_bf16_f32 v63, v62, v63
    v_lshlrev_b32 v62, 16, v63
    v_and_b32 v63, s93, v63
    v_mul_f32 v62, s7, v62
    v_mul_f32 v63, s7, v63
    v_cvt_pk_bf16_f32 v25, v62, v63
    v_lshlrev_b32 v64, 16, v26
    v_and_b32 v65, s93, v26
    v_subrev_f32 v64, s6, v64
    v_subrev_f32 v65, s6, v65
    v_cvt_pk_bf16_f32 v65, v64, v65
    v_lshlrev_b32 v64, 16, v65
    v_and_b32 v65, s93, v65
    v_mul_f32 v64, s7, v64
    v_mul_f32 v65, s7, v65
    v_cvt_pk_bf16_f32 v26, v64, v65
    v_lshlrev_b32 v66, 16, v27
    v_and_b32 v67, s93, v27
    v_subrev_f32 v66, s6, v66
    v_subrev_f32 v67, s6, v67
    v_cvt_pk_bf16_f32 v67, v66, v67
    v_lshlrev_b32 v66, 16, v67
    v_and_b32 v67, s93, v67
    v_mul_f32 v66, s7, v66
    v_mul_f32 v67, s7, v67
    v_cvt_pk_bf16_f32 v27, v66, v67
    v_lshlrev_b32 v60, 16, v28
    v_and_b32 v61, s93, v28
    v_subrev_f32 v60, s6, v60
    v_subrev_f32 v61, s6, v61
    v_cvt_pk_bf16_f32 v61, v60, v61
    v_lshlrev_b32 v60, 16, v61
    v_and_b32 v61, s93, v61
    v_mul_f32 v60, s7, v60
    v_mul_f32 v61, s7, v61
    v_cvt_pk_bf16_f32 v28, v60, v61
    v_lshlrev_b32 v62, 16, v29
    v_and_b32 v63, s93, v29
    v_subrev_f32 v62, s6, v62
    v_subrev_f32 v63, s6, v63
    v_cvt_pk_bf16_f32 v63, v62, v63
    v_lshlrev_b32 v62, 16, v63
    v_and_b32 v63, s93, v63
    v_mul_f32 v62, s7, v62
    v_mul_f32 v63, s7, v63
    v_cvt_pk_bf16_f32 v29, v62, v63
    v_lshlrev_b32 v64, 16, v30
    v_and_b32 v65, s93, v30
    v_subrev_f32 v64, s6, v64
    v_subrev_f32 v65, s6, v65
    v_cvt_pk_bf16_f32 v65, v64, v65
    v_lshlrev_b32 v64, 16, v65
    v_and_b32 v65, s93, v65
    v_mul_f32 v64, s7, v64
    v_mul_f32 v65, s7, v65
    v_cvt_pk_bf16_f32 v30, v64, v65
    v_lshlrev_b32 v66, 16, v31
    v_and_b32 v67, s93, v31
    v_subrev_f32 v66, s6, v66
    v_subrev_f32 v67, s6, v67
    v_cvt_pk_bf16_f32 v67, v66, v67
    v_lshlrev_b32 v66, 16, v67
    v_and_b32 v67, s93, v67
    v_mul_f32 v66, s7, v66
    v_mul_f32 v67, s7, v67
    v_cvt_pk_bf16_f32 v31, v66, v67
    ds_write_b128 v9, v[16:19] offset:0
    ds_write_b128 v9, v[20:23] offset:1024
    ds_write_b128 v9, v[24:27] offset:2048
    ds_write_b128 v9, v[28:31] offset:3072
    v_lshlrev_b32 v8, 3, v0
    v_add_u32 v8, 67072, v8
    v_mov_b32 v56, 0
    v_mov_b32 v57, 0
    v_dot2_f32_bf16 v56, v16, v32, v56
    v_dot2_f32_bf16 v57, v24, v32, v57
    v_dot2_f32_bf16 v56, v17, v33, v56
    v_dot2_f32_bf16 v57, v25, v33, v57
    v_dot2_f32_bf16 v56, v18, v34, v56
    v_dot2_f32_bf16 v57, v26, v34, v57
    v_dot2_f32_bf16 v56, v19, v35, v56
    v_dot2_f32_bf16 v57, v27, v35, v57
    v_dot2_f32_bf16 v56, v20, v36, v56
    v_dot2_f32_bf16 v57, v28, v36, v57
    v_dot2_f32_bf16 v56, v21, v37, v56
    v_dot2_f32_bf16 v57, v29, v37, v57
    v_dot2_f32_bf16 v56, v22, v38, v56
    v_dot2_f32_bf16 v57, v30, v38, v57
    v_dot2_f32_bf16 v56, v23, v39, v56
    v_dot2_f32_bf16 v57, v31, v39, v57
    s_nop 1
    v_add_f32_dpp v56, v56, v56 row_ror:1 row_mask:0xf bank_mask:0xf
    v_add_f32_dpp v57, v57, v57 row_ror:1 row_mask:0xf bank_mask:0xf
    s_nop 0
    v_add_f32_dpp v56, v56, v56 row_ror:2 row_mask:0xf bank_mask:0xf
    v_add_f32_dpp v57, v57, v57 row_ror:2 row_mask:0xf bank_mask:0xf
    s_nop 0
    v_add_f32_dpp v56, v56, v56 row_ror:4 row_mask:0xf bank_mask:0xf
    v_add_f32_dpp v57, v57, v57 row_ror:4 row_mask:0xf bank_mask:0xf
    s_nop 0
    v_add_f32_dpp v56, v56, v56 row_ror:8 row_mask:0xf bank_mask:0xf
    v_add_f32_dpp v57, v57, v57 row_ror:8 row_mask:0xf bank_mask:0xf
    s_nop 0
    v_add_f32_dpp v56, v56, v56 row_bcast:15 row_mask:0xa bank_mask:0xf
    v_add_f32_dpp v57, v57, v57 row_bcast:15 row_mask:0xa bank_mask:0xf
    s_nop 0
    v_add_f32_dpp v56, v56, v56 row_bcast:31 row_mask:0xc bank_mask:0xf
    v_add_f32_dpp v57, v57, v57 row_bcast:31 row_mask:0xc bank_mask:0xf
    s_lshl_b32 s92, s2, 3
    s_lshl1_add_u32 s92, s98, s92
    s_sub_u32 s8, 2047, s92
    s_sub_u32 s9, 2046, s92
    v_cvt_pk_bf16_f32 v56, v56, v56
    v_lshlrev_b32 v56, 16, v56
    v_ashrrev_i32 v58, 31, v56
    v_or_b32 v58, 0x80000000, v58
    v_xor_b32 v58, v58, v56
    v_and_b32 v58, s93, v58
    v_or_b32 v56, s8, v58
    v_cvt_pk_bf16_f32 v57, v57, v57
    v_lshlrev_b32 v57, 16, v57
    v_ashrrev_i32 v58, 31, v57
    v_or_b32 v58, 0x80000000, v58
    v_xor_b32 v58, v58, v57
    v_and_b32 v58, s93, v58
    v_or_b32 v57, s9, v58
    v_mov_b32 v60, s4
    v_mov_b32 v61, s5
    v_mov_b32 v62, s6
    v_mov_b32 v63, s7
    s_lshl_b32 s92, s98, 3
    s_add_u32 s8, s92, 158912
    s_lshl1_add_u32 s9, s92, 158848
    v_mov_b32 v10, s8
    v_mov_b32 v12, s9
    v_mov_b32 v13, 158848
    s_mov_b32 exec_lo, 0
    s_mov_b32 exec_hi, 0x80000000
    ds_write_b64 v10, v[56:57]
    ds_write_b128 v12, v[60:63]
    s_waitcnt vmcnt(0)
    s_mov_b64 exec, 1
    ds_add_u32 v2, v3 offset:12
    s_mov_b64 exec, -1
    s_cmp_lt_u32 s3, 6
    s_cbranch_scc1 L37
    s_cmp_ge_u32 s0, 224
    s_cbranch_scc1 L37
    v_lshrrev_b32 v10, 3, v1
    v_and_b32 v4, 6, v10
    v_mul_u32_u24 v10, 7168, v10
    v_xor_b32 v4, v4, v1
    v_and_b32 v4, 7, v4
    s_and_b32 s91, s97, 3
    s_mul_i32 s91, s91, 1834976
    s_lshl_b32 s92, s97, 5
    s_add_u32 s92, s92, s91
    v_lshl_add_u32 v4, v4, 4, s92
    v_add_u32 v10, v10, v4
    s_and_b32 s12, s3, 1
    L36:
    s_lshl_b32 s92, s12, 10
    s_add_u32 m0, s92, 85120
    s_mul_i32 s92, s12, 57344
    buffer_load_dwordx4 v10, s[40:43], s92 offen nt lds
    s_add_u32 m0, m0, 32768
    s_add_u32 s12, s12, 2
    buffer_load_dwordx4 v10, s[44:47], s92 offen nt lds
    s_cmp_lt_u32 s12, 6
    s_cbranch_scc1 L36
L37:
    s_mov_b32 s91, 0x40000
L38:
    ds_read_b32 v4, v2 offset:12
    s_sub_u32 s91, s91, 1
    s_cbranch_scc1 L39
    s_waitcnt lgkmcnt(0)
    v_readfirstlane_b32 s92, v4
    s_cmp_lt_u32 s92, 4
    s_cbranch_scc1 L38
L39:
    ds_read_b128 v[152:155], v13 offset:64
    ds_read_b128 v[156:159], v13 offset:80
    ds_read_b64 v[136:137], v8 offset:34432
    ds_read_b64 v[138:139], v8 offset:36480
    ds_read_b64 v[140:141], v8 offset:38528
    ds_read_b64 v[142:143], v8 offset:40576
    ds_read_b64 v[144:145], v8 offset:42624
    ds_read_b64 v[146:147], v8 offset:44672
    ds_read_b64 v[148:149], v8 offset:46720
    ds_read_b64 v[150:151], v8 offset:48768
    s_cmp_lg_u32 s3, 4
    s_cbranch_scc1 L40
    s_lshl_b32 s92, s2, 4
    s_add_u32 s92, s92, 6291456
    v_lshl_add_u32 v10, v1, 12, s92
    v_add_u32 v58, 1, v71
    v_add_u32 v59, 1, v71
    s_waitcnt lgkmcnt(8)
    v_max_u32 v56, v152, v153
    v_min_u32 v57, v152, v153
    v_med3_u32 v57, v56, v57, v154
    v_max_u32 v56, v56, v154
    v_med3_u32 v57, v56, v57, v155
    v_max_u32 v56, v56, v155
    v_med3_u32 v57, v56, v57, v156
    v_max_u32 v56, v56, v156
    v_med3_u32 v57, v56, v57, v157
    v_max_u32 v56, v56, v157
    v_med3_u32 v57, v56, v57, v158
    v_max_u32 v56, v56, v158
    v_med3_u32 v57, v56, v57, v159
    v_max_u32 v56, v56, v159
    s_mov_b64 exec, 65535
    buffer_store_dwordx4 v[56:59], v10, s[56:59], 0 offen sc1
    s_mov_b64 exec, -1
L40:
    ds_read_b64 v[200:201], v8 offset:0
    ds_read_b64 v[202:203], v8 offset:2048
    ds_read_b64 v[204:205], v8 offset:4640
    ds_read_b64 v[206:207], v8 offset:6688
    ds_read_b64 v[208:209], v8 offset:9280
    ds_read_b64 v[210:211], v8 offset:11328
    ds_read_b64 v[212:213], v8 offset:13920
    ds_read_b64 v[214:215], v8 offset:15968
    s_mov_b64 exec, 1
    ds_add_u32 v2, v3 offset:0
    s_mov_b64 exec, -1
    s_waitcnt lgkmcnt(0)
    s_cmp_ge_u32 s3, 6
    s_cbranch_scc1 L41
    s_mov_b32 s8, 0xbfb8aa3b
    s_mov_b32 s9, 1.0
    v_lshlrev_b32 v72, 16, v200
    v_and_b32 v73, s93, v200
    v_lshlrev_b32 v74, 16, v201
    v_and_b32 v75, s93, v201
    v_lshlrev_b32 v60, 16, v136
    v_and_b32 v61, s93, v136
    v_lshlrev_b32 v64, 16, v137
    v_and_b32 v65, s93, v137
    v_mul_f32 v62, s8, v60
    v_mul_f32 v63, s8, v61
    v_exp_f32 v62, v62
    v_exp_f32 v63, v63
    v_pk_mul_f32 v[104:105], v[60:61], v[60:61]
    v_mul_f32 v66, s8, v64
    v_mul_f32 v67, s8, v65
    v_exp_f32 v66, v66
    v_exp_f32 v67, v67
    v_pk_mul_f32 v[106:107], v[64:65], v[64:65]
    v_add_f32 v62, 1.0, v62
    v_add_f32 v63, 1.0, v63
    v_rcp_f32 v62, v62
    v_rcp_f32 v63, v63
    v_add_f32 v66, 1.0, v66
    v_add_f32 v67, 1.0, v67
    v_rcp_f32 v66, v66
    v_rcp_f32 v67, v67
    v_pk_mul_f32 v[104:105], v[104:105], v[62:63]
    v_pk_mul_f32 v[106:107], v[106:107], v[66:67]
    v_lshlrev_b32 v76, 16, v202
    v_and_b32 v77, s93, v202
    v_lshlrev_b32 v78, 16, v203
    v_and_b32 v79, s93, v203
    v_lshlrev_b32 v60, 16, v138
    v_and_b32 v61, s93, v138
    v_lshlrev_b32 v64, 16, v139
    v_and_b32 v65, s93, v139
    v_mul_f32 v62, s8, v60
    v_mul_f32 v63, s8, v61
    v_exp_f32 v62, v62
    v_exp_f32 v63, v63
    v_pk_mul_f32 v[108:109], v[60:61], v[60:61]
    v_mul_f32 v66, s8, v64
    v_mul_f32 v67, s8, v65
    v_exp_f32 v66, v66
    v_exp_f32 v67, v67
    v_pk_mul_f32 v[110:111], v[64:65], v[64:65]
    v_add_f32 v62, 1.0, v62
    v_add_f32 v63, 1.0, v63
    v_rcp_f32 v62, v62
    v_rcp_f32 v63, v63
    v_add_f32 v66, 1.0, v66
    v_add_f32 v67, 1.0, v67
    v_rcp_f32 v66, v66
    v_rcp_f32 v67, v67
    v_pk_mul_f32 v[108:109], v[108:109], v[62:63]
    v_pk_mul_f32 v[110:111], v[110:111], v[66:67]
    v_lshlrev_b32 v80, 16, v204
    v_and_b32 v81, s93, v204
    v_lshlrev_b32 v82, 16, v205
    v_and_b32 v83, s93, v205
    v_lshlrev_b32 v60, 16, v140
    v_and_b32 v61, s93, v140
    v_lshlrev_b32 v64, 16, v141
    v_and_b32 v65, s93, v141
    v_mul_f32 v62, s8, v60
    v_mul_f32 v63, s8, v61
    v_exp_f32 v62, v62
    v_exp_f32 v63, v63
    v_pk_mul_f32 v[112:113], v[60:61], v[60:61]
    v_mul_f32 v66, s8, v64
    v_mul_f32 v67, s8, v65
    v_exp_f32 v66, v66
    v_exp_f32 v67, v67
    v_pk_mul_f32 v[114:115], v[64:65], v[64:65]
    v_add_f32 v62, 1.0, v62
    v_add_f32 v63, 1.0, v63
    v_rcp_f32 v62, v62
    v_rcp_f32 v63, v63
    v_add_f32 v66, 1.0, v66
    v_add_f32 v67, 1.0, v67
    v_rcp_f32 v66, v66
    v_rcp_f32 v67, v67
    v_pk_mul_f32 v[112:113], v[112:113], v[62:63]
    v_pk_mul_f32 v[114:115], v[114:115], v[66:67]
    v_lshlrev_b32 v84, 16, v206
    v_and_b32 v85, s93, v206
    v_lshlrev_b32 v86, 16, v207
    v_and_b32 v87, s93, v207
    v_lshlrev_b32 v60, 16, v142
    v_and_b32 v61, s93, v142
    v_lshlrev_b32 v64, 16, v143
    v_and_b32 v65, s93, v143
    v_mul_f32 v62, s8, v60
    v_mul_f32 v63, s8, v61
    v_exp_f32 v62, v62
    v_exp_f32 v63, v63
    v_pk_mul_f32 v[116:117], v[60:61], v[60:61]
    v_mul_f32 v66, s8, v64
    v_mul_f32 v67, s8, v65
    v_exp_f32 v66, v66
    v_exp_f32 v67, v67
    v_pk_mul_f32 v[118:119], v[64:65], v[64:65]
    v_add_f32 v62, 1.0, v62
    v_add_f32 v63, 1.0, v63
    v_rcp_f32 v62, v62
    v_rcp_f32 v63, v63
    v_add_f32 v66, 1.0, v66
    v_add_f32 v67, 1.0, v67
    v_rcp_f32 v66, v66
    v_rcp_f32 v67, v67
    v_pk_mul_f32 v[116:117], v[116:117], v[62:63]
    v_pk_mul_f32 v[118:119], v[118:119], v[66:67]
    v_lshlrev_b32 v88, 16, v208
    v_and_b32 v89, s93, v208
    v_lshlrev_b32 v90, 16, v209
    v_and_b32 v91, s93, v209
    v_lshlrev_b32 v60, 16, v144
    v_and_b32 v61, s93, v144
    v_lshlrev_b32 v64, 16, v145
    v_and_b32 v65, s93, v145
    v_mul_f32 v62, s8, v60
    v_mul_f32 v63, s8, v61
    v_exp_f32 v62, v62
    v_exp_f32 v63, v63
    v_pk_mul_f32 v[120:121], v[60:61], v[60:61]
    v_mul_f32 v66, s8, v64
    v_mul_f32 v67, s8, v65
    v_exp_f32 v66, v66
    v_exp_f32 v67, v67
    v_pk_mul_f32 v[122:123], v[64:65], v[64:65]
    v_add_f32 v62, 1.0, v62
    v_add_f32 v63, 1.0, v63
    v_rcp_f32 v62, v62
    v_rcp_f32 v63, v63
    v_add_f32 v66, 1.0, v66
    v_add_f32 v67, 1.0, v67
    v_rcp_f32 v66, v66
    v_rcp_f32 v67, v67
    v_pk_mul_f32 v[120:121], v[120:121], v[62:63]
    v_pk_mul_f32 v[122:123], v[122:123], v[66:67]
    v_lshlrev_b32 v92, 16, v210
    v_and_b32 v93, s93, v210
    v_lshlrev_b32 v94, 16, v211
    v_and_b32 v95, s93, v211
    v_lshlrev_b32 v60, 16, v146
    v_and_b32 v61, s93, v146
    v_lshlrev_b32 v64, 16, v147
    v_and_b32 v65, s93, v147
    v_mul_f32 v62, s8, v60
    v_mul_f32 v63, s8, v61
    v_exp_f32 v62, v62
    v_exp_f32 v63, v63
    v_pk_mul_f32 v[124:125], v[60:61], v[60:61]
    v_mul_f32 v66, s8, v64
    v_mul_f32 v67, s8, v65
    v_exp_f32 v66, v66
    v_exp_f32 v67, v67
    v_pk_mul_f32 v[126:127], v[64:65], v[64:65]
    v_add_f32 v62, 1.0, v62
    v_add_f32 v63, 1.0, v63
    v_rcp_f32 v62, v62
    v_rcp_f32 v63, v63
    v_add_f32 v66, 1.0, v66
    v_add_f32 v67, 1.0, v67
    v_rcp_f32 v66, v66
    v_rcp_f32 v67, v67
    v_pk_mul_f32 v[124:125], v[124:125], v[62:63]
    v_pk_mul_f32 v[126:127], v[126:127], v[66:67]
    v_lshlrev_b32 v96, 16, v212
    v_and_b32 v97, s93, v212
    v_lshlrev_b32 v98, 16, v213
    v_and_b32 v99, s93, v213
    v_lshlrev_b32 v60, 16, v148
    v_and_b32 v61, s93, v148
    v_lshlrev_b32 v64, 16, v149
    v_and_b32 v65, s93, v149
    v_mul_f32 v62, s8, v60
    v_mul_f32 v63, s8, v61
    v_exp_f32 v62, v62
    v_exp_f32 v63, v63
    v_pk_mul_f32 v[128:129], v[60:61], v[60:61]
    v_mul_f32 v66, s8, v64
    v_mul_f32 v67, s8, v65
    v_exp_f32 v66, v66
    v_exp_f32 v67, v67
    v_pk_mul_f32 v[130:131], v[64:65], v[64:65]
    v_add_f32 v62, 1.0, v62
    v_add_f32 v63, 1.0, v63
    v_rcp_f32 v62, v62
    v_rcp_f32 v63, v63
    v_add_f32 v66, 1.0, v66
    v_add_f32 v67, 1.0, v67
    v_rcp_f32 v66, v66
    v_rcp_f32 v67, v67
    v_pk_mul_f32 v[128:129], v[128:129], v[62:63]
    v_pk_mul_f32 v[130:131], v[130:131], v[66:67]
    v_lshlrev_b32 v100, 16, v214
    v_and_b32 v101, s93, v214
    v_lshlrev_b32 v102, 16, v215
    v_and_b32 v103, s93, v215
    v_lshlrev_b32 v60, 16, v150
    v_and_b32 v61, s93, v150
    v_lshlrev_b32 v64, 16, v151
    v_and_b32 v65, s93, v151
    v_mul_f32 v62, s8, v60
    v_mul_f32 v63, s8, v61
    v_exp_f32 v62, v62
    v_exp_f32 v63, v63
    v_pk_mul_f32 v[132:133], v[60:61], v[60:61]
    v_mul_f32 v66, s8, v64
    v_mul_f32 v67, s8, v65
    v_exp_f32 v66, v66
    v_exp_f32 v67, v67
    v_pk_mul_f32 v[134:135], v[64:65], v[64:65]
    v_add_f32 v62, 1.0, v62
    v_add_f32 v63, 1.0, v63
    v_rcp_f32 v62, v62
    v_rcp_f32 v63, v63
    v_add_f32 v66, 1.0, v66
    v_add_f32 v67, 1.0, v67
    v_rcp_f32 v66, v66
    v_rcp_f32 v67, v67
    v_pk_mul_f32 v[132:133], v[132:133], v[62:63]
    v_pk_mul_f32 v[134:135], v[134:135], v[66:67]
    s_branch L42
L41:
    s_mov_b32 s8, 0xbfb8aa3b
    s_mov_b32 s9, 1.0
    v_lshlrev_b32 v72, 16, v200
    v_and_b32 v73, s93, v200
    v_lshlrev_b32 v74, 16, v201
    v_and_b32 v75, s93, v201
    v_lshlrev_b32 v60, 16, v136
    v_and_b32 v61, s93, v136
    v_lshlrev_b32 v64, 16, v137
    v_and_b32 v65, s93, v137
    v_mul_f32 v62, s8, v60
    v_mul_f32 v63, s8, v61
    v_exp_f32 v62, v62
    v_exp_f32 v63, v63
    v_pk_mul_f32 v[104:105], v[60:61], v[60:61]
    v_mul_f32 v66, s8, v64
    v_mul_f32 v67, s8, v65
    v_exp_f32 v66, v66
    v_exp_f32 v67, v67
    v_pk_mul_f32 v[106:107], v[64:65], v[64:65]
    v_add_f32 v62, 1.0, v62
    v_add_f32 v63, 1.0, v63
    v_rcp_f32 v62, v62
    v_rcp_f32 v63, v63
    v_add_f32 v66, 1.0, v66
    v_add_f32 v67, 1.0, v67
    v_rcp_f32 v66, v66
    v_rcp_f32 v67, v67
    v_pk_mul_f32 v[104:105], v[104:105], v[62:63]
    v_pk_mul_f32 v[106:107], v[106:107], v[66:67]
    s_cmp_ge_u32 s0, 224
    s_cbranch_scc1 L44
    s_lshl_b32 s92, s12, 10
    s_add_u32 m0, s92, 85120
    s_mul_i32 s92, s12, 57344
    buffer_load_dwordx4 v10, s[40:43], s92 offen nt lds
    s_add_u32 m0, m0, 32768
    s_add_u32 s12, s12, 2
    buffer_load_dwordx4 v10, s[44:47], s92 offen nt lds
L44:
    v_lshlrev_b32 v76, 16, v202
    v_and_b32 v77, s93, v202
    v_lshlrev_b32 v78, 16, v203
    v_and_b32 v79, s93, v203
    v_lshlrev_b32 v60, 16, v138
    v_and_b32 v61, s93, v138
    v_lshlrev_b32 v64, 16, v139
    v_and_b32 v65, s93, v139
    v_mul_f32 v62, s8, v60
    v_mul_f32 v63, s8, v61
    v_exp_f32 v62, v62
    v_exp_f32 v63, v63
    v_pk_mul_f32 v[108:109], v[60:61], v[60:61]
    v_mul_f32 v66, s8, v64
    v_mul_f32 v67, s8, v65
    v_exp_f32 v66, v66
    v_exp_f32 v67, v67
    v_pk_mul_f32 v[110:111], v[64:65], v[64:65]
    v_add_f32 v62, 1.0, v62
    v_add_f32 v63, 1.0, v63
    v_rcp_f32 v62, v62
    v_rcp_f32 v63, v63
    v_add_f32 v66, 1.0, v66
    v_add_f32 v67, 1.0, v67
    v_rcp_f32 v66, v66
    v_rcp_f32 v67, v67
    v_pk_mul_f32 v[108:109], v[108:109], v[62:63]
    v_pk_mul_f32 v[110:111], v[110:111], v[66:67]
    v_lshlrev_b32 v80, 16, v204
    v_and_b32 v81, s93, v204
    v_lshlrev_b32 v82, 16, v205
    v_and_b32 v83, s93, v205
    v_lshlrev_b32 v60, 16, v140
    v_and_b32 v61, s93, v140
    v_lshlrev_b32 v64, 16, v141
    v_and_b32 v65, s93, v141
    v_mul_f32 v62, s8, v60
    v_mul_f32 v63, s8, v61
    v_exp_f32 v62, v62
    v_exp_f32 v63, v63
    v_pk_mul_f32 v[112:113], v[60:61], v[60:61]
    v_mul_f32 v66, s8, v64
    v_mul_f32 v67, s8, v65
    v_exp_f32 v66, v66
    v_exp_f32 v67, v67
    v_pk_mul_f32 v[114:115], v[64:65], v[64:65]
    v_add_f32 v62, 1.0, v62
    v_add_f32 v63, 1.0, v63
    v_rcp_f32 v62, v62
    v_rcp_f32 v63, v63
    v_add_f32 v66, 1.0, v66
    v_add_f32 v67, 1.0, v67
    v_rcp_f32 v66, v66
    v_rcp_f32 v67, v67
    v_pk_mul_f32 v[112:113], v[112:113], v[62:63]
    v_pk_mul_f32 v[114:115], v[114:115], v[66:67]
    s_cmp_ge_u32 s0, 224
    s_cbranch_scc1 L46
    s_lshl_b32 s92, s12, 10
    s_add_u32 m0, s92, 85120
    s_mul_i32 s92, s12, 57344
    buffer_load_dwordx4 v10, s[40:43], s92 offen nt lds
    s_add_u32 m0, m0, 32768
    s_add_u32 s12, s12, 2
    buffer_load_dwordx4 v10, s[44:47], s92 offen nt lds
L46:
    v_lshlrev_b32 v84, 16, v206
    v_and_b32 v85, s93, v206
    v_lshlrev_b32 v86, 16, v207
    v_and_b32 v87, s93, v207
    v_lshlrev_b32 v60, 16, v142
    v_and_b32 v61, s93, v142
    v_lshlrev_b32 v64, 16, v143
    v_and_b32 v65, s93, v143
    v_mul_f32 v62, s8, v60
    v_mul_f32 v63, s8, v61
    v_exp_f32 v62, v62
    v_exp_f32 v63, v63
    v_pk_mul_f32 v[116:117], v[60:61], v[60:61]
    v_mul_f32 v66, s8, v64
    v_mul_f32 v67, s8, v65
    v_exp_f32 v66, v66
    v_exp_f32 v67, v67
    v_pk_mul_f32 v[118:119], v[64:65], v[64:65]
    v_add_f32 v62, 1.0, v62
    v_add_f32 v63, 1.0, v63
    v_rcp_f32 v62, v62
    v_rcp_f32 v63, v63
    v_add_f32 v66, 1.0, v66
    v_add_f32 v67, 1.0, v67
    v_rcp_f32 v66, v66
    v_rcp_f32 v67, v67
    v_pk_mul_f32 v[116:117], v[116:117], v[62:63]
    v_pk_mul_f32 v[118:119], v[118:119], v[66:67]
    v_lshlrev_b32 v88, 16, v208
    v_and_b32 v89, s93, v208
    v_lshlrev_b32 v90, 16, v209
    v_and_b32 v91, s93, v209
    v_lshlrev_b32 v60, 16, v144
    v_and_b32 v61, s93, v144
    v_lshlrev_b32 v64, 16, v145
    v_and_b32 v65, s93, v145
    v_mul_f32 v62, s8, v60
    v_mul_f32 v63, s8, v61
    v_exp_f32 v62, v62
    v_exp_f32 v63, v63
    v_pk_mul_f32 v[120:121], v[60:61], v[60:61]
    v_mul_f32 v66, s8, v64
    v_mul_f32 v67, s8, v65
    v_exp_f32 v66, v66
    v_exp_f32 v67, v67
    v_pk_mul_f32 v[122:123], v[64:65], v[64:65]
    v_add_f32 v62, 1.0, v62
    v_add_f32 v63, 1.0, v63
    v_rcp_f32 v62, v62
    v_rcp_f32 v63, v63
    v_add_f32 v66, 1.0, v66
    v_add_f32 v67, 1.0, v67
    v_rcp_f32 v66, v66
    v_rcp_f32 v67, v67
    v_pk_mul_f32 v[120:121], v[120:121], v[62:63]
    v_pk_mul_f32 v[122:123], v[122:123], v[66:67]
    s_cmp_ge_u32 s0, 224
    s_cbranch_scc1 L48
    s_lshl_b32 s92, s12, 10
    s_add_u32 m0, s92, 85120
    s_mul_i32 s92, s12, 57344
    buffer_load_dwordx4 v10, s[40:43], s92 offen nt lds
    s_add_u32 m0, m0, 32768
    s_add_u32 s12, s12, 2
    buffer_load_dwordx4 v10, s[44:47], s92 offen nt lds
L48:
    v_lshlrev_b32 v92, 16, v210
    v_and_b32 v93, s93, v210
    v_lshlrev_b32 v94, 16, v211
    v_and_b32 v95, s93, v211
    v_lshlrev_b32 v60, 16, v146
    v_and_b32 v61, s93, v146
    v_lshlrev_b32 v64, 16, v147
    v_and_b32 v65, s93, v147
    v_mul_f32 v62, s8, v60
    v_mul_f32 v63, s8, v61
    v_exp_f32 v62, v62
    v_exp_f32 v63, v63
    v_pk_mul_f32 v[124:125], v[60:61], v[60:61]
    v_mul_f32 v66, s8, v64
    v_mul_f32 v67, s8, v65
    v_exp_f32 v66, v66
    v_exp_f32 v67, v67
    v_pk_mul_f32 v[126:127], v[64:65], v[64:65]
    v_add_f32 v62, 1.0, v62
    v_add_f32 v63, 1.0, v63
    v_rcp_f32 v62, v62
    v_rcp_f32 v63, v63
    v_add_f32 v66, 1.0, v66
    v_add_f32 v67, 1.0, v67
    v_rcp_f32 v66, v66
    v_rcp_f32 v67, v67
    v_pk_mul_f32 v[124:125], v[124:125], v[62:63]
    v_pk_mul_f32 v[126:127], v[126:127], v[66:67]
    v_lshlrev_b32 v96, 16, v212
    v_and_b32 v97, s93, v212
    v_lshlrev_b32 v98, 16, v213
    v_and_b32 v99, s93, v213
    v_lshlrev_b32 v60, 16, v148
    v_and_b32 v61, s93, v148
    v_lshlrev_b32 v64, 16, v149
    v_and_b32 v65, s93, v149
    v_mul_f32 v62, s8, v60
    v_mul_f32 v63, s8, v61
    v_exp_f32 v62, v62
    v_exp_f32 v63, v63
    v_pk_mul_f32 v[128:129], v[60:61], v[60:61]
    v_mul_f32 v66, s8, v64
    v_mul_f32 v67, s8, v65
    v_exp_f32 v66, v66
    v_exp_f32 v67, v67
    v_pk_mul_f32 v[130:131], v[64:65], v[64:65]
    v_add_f32 v62, 1.0, v62
    v_add_f32 v63, 1.0, v63
    v_rcp_f32 v62, v62
    v_rcp_f32 v63, v63
    v_add_f32 v66, 1.0, v66
    v_add_f32 v67, 1.0, v67
    v_rcp_f32 v66, v66
    v_rcp_f32 v67, v67
    v_pk_mul_f32 v[128:129], v[128:129], v[62:63]
    v_pk_mul_f32 v[130:131], v[130:131], v[66:67]
    s_cmp_ge_u32 s0, 224
    s_cbranch_scc1 L50
    s_lshl_b32 s92, s12, 10
    s_add_u32 m0, s92, 85120
    s_mul_i32 s92, s12, 57344
    buffer_load_dwordx4 v10, s[40:43], s92 offen nt lds
    s_add_u32 m0, m0, 32768
    s_add_u32 s12, s12, 2
    buffer_load_dwordx4 v10, s[44:47], s92 offen nt lds
L50:
    v_lshlrev_b32 v100, 16, v214
    v_and_b32 v101, s93, v214
    v_lshlrev_b32 v102, 16, v215
    v_and_b32 v103, s93, v215
    v_lshlrev_b32 v60, 16, v150
    v_and_b32 v61, s93, v150
    v_lshlrev_b32 v64, 16, v151
    v_and_b32 v65, s93, v151
    v_mul_f32 v62, s8, v60
    v_mul_f32 v63, s8, v61
    v_exp_f32 v62, v62
    v_exp_f32 v63, v63
    v_pk_mul_f32 v[132:133], v[60:61], v[60:61]
    v_mul_f32 v66, s8, v64
    v_mul_f32 v67, s8, v65
    v_exp_f32 v66, v66
    v_exp_f32 v67, v67
    v_pk_mul_f32 v[134:135], v[64:65], v[64:65]
    v_add_f32 v62, 1.0, v62
    v_add_f32 v63, 1.0, v63
    v_rcp_f32 v62, v62
    v_rcp_f32 v63, v63
    v_add_f32 v66, 1.0, v66
    v_add_f32 v67, 1.0, v67
    v_rcp_f32 v66, v66
    v_rcp_f32 v67, v67
    v_pk_mul_f32 v[132:133], v[132:133], v[62:63]
    v_pk_mul_f32 v[134:135], v[134:135], v[66:67]
    s_mov_b32 s91, 0x40000
L52:
    ds_read_b32 v4, v2 offset:0
    s_sub_u32 s91, s91, 1
    s_cbranch_scc1 L53
    s_waitcnt lgkmcnt(0)
    v_readfirstlane_b32 s92, v4
    s_cmp_lt_u32 s92, 4
    s_cbranch_scc1 L52
L53:
    s_cmp_ge_u32 s0, 224
    s_cbranch_scc1 L42
L51:
    s_waitcnt vmcnt(6)
    s_lshl_b32 s92, s12, 10
    s_add_u32 m0, s92, 85120
    s_mul_i32 s92, s12, 57344
    buffer_load_dwordx4 v10, s[40:43], s92 offen nt lds
    s_add_u32 m0, m0, 32768
    s_add_u32 s12, s12, 2
    buffer_load_dwordx4 v10, s[44:47], s92 offen nt lds
    s_cmp_lt_u32 s12, 32
    s_cbranch_scc1 L51
L42:
    s_cmp_ge_u32 s3, 6
    s_cbranch_scc1 L54
    s_and_b32 s92, s2, 15
    v_readlane_b32 s14, v71, s92
    s_lshl_b32 s92, s92, 12
    s_add_u32 s14, s14, 1
    s_add_u32 s92, s92, 6291456
    v_add_u32 v10, s92, v11
    s_and_b32 s13, s97, 3
    s_lshl_b32 s13, s13, 9
    v_lshl_add_u32 v8, v1, 3, s13
    s_lshl_b32 s92, s98, 11
    s_add_u32 s92, s92, 150656
    v_add_u32 v9, s92, v8
    s_lshl3_add_u32 s92, s98, 158848
    v_mov_b32 v14, s92
    s_lshl2_add_u32 s92, s98, 158944
    v_mov_b32 v15, s92
    s_mov_b32 s91, 0x40000
L55:
    ds_read_b32 v4, v2 offset:4
    s_sub_u32 s91, s91, 1
    s_cbranch_scc1 L56
    s_waitcnt lgkmcnt(0)
    v_readfirstlane_b32 s92, v4
    s_cmp_lt_u32 s92, 4
    s_cbranch_scc1 L55
L56:
    s_mov_b32 s91, 8192
    buffer_load_dwordx4 v[16:19], v10, s[56:59], 0 offen offset:0 sc1
    buffer_load_dwordx4 v[20:23], v10, s[56:59], 0 offen offset:1024 sc1
    buffer_load_dwordx4 v[24:27], v10, s[56:59], 0 offen offset:2048 sc1
    buffer_load_dwordx4 v[28:31], v10, s[56:59], 0 offen offset:3072 sc1
    s_branch L58
L57:
    s_mov_b64 exec, s[20:21]
    s_cbranch_execz L60
    buffer_load_dwordx4 v[16:19], v10, s[56:59], 0 offen offset:0 sc1
L60:
    s_mov_b64 exec, s[22:23]
    s_cbranch_execz L61
    buffer_load_dwordx4 v[20:23], v10, s[56:59], 0 offen offset:1024 sc1
L61:
    s_mov_b64 exec, s[24:25]
    s_cbranch_execz L62
    buffer_load_dwordx4 v[24:27], v10, s[56:59], 0 offen offset:2048 sc1
L62:
    s_mov_b64 exec, s[26:27]
    s_cbranch_execz L63
    buffer_load_dwordx4 v[28:31], v10, s[56:59], 0 offen offset:3072 sc1
L63:
    s_mov_b64 exec, -1
L58:
    s_sub_u32 s91, s91, 1
    s_waitcnt vmcnt(0)
    s_cbranch_scc1 L59
    v_cmp_ne_u32 s[20:21], s14, v18
    v_cmp_ne_u32 s[22:23], s14, v22
    v_cmp_ne_u32 s[24:25], s14, v26
    v_cmp_ne_u32 s[26:27], s14, v30
    s_or_b64 vcc, s[20:21], s[22:23]
    s_or_b64 vcc, vcc, s[24:25]
    s_or_b64 vcc, vcc, s[26:27]
    s_cbranch_scc1 L57
L59:
    s_setprio 3
    v_max_u32 v56, v16, v17
    v_min_u32 v57, v16, v17
    v_med3_u32 v57, v56, v57, v20
    v_max_u32 v56, v56, v20
    v_med3_u32 v57, v56, v57, v21
    v_max_u32 v56, v56, v21
    v_med3_u32 v57, v56, v57, v24
    v_max_u32 v56, v56, v24
    v_med3_u32 v57, v56, v57, v25
    v_max_u32 v56, v56, v25
    v_med3_u32 v57, v56, v57, v28
    v_max_u32 v56, v56, v28
    v_med3_u32 v57, v56, v57, v29
    v_max_u32 v56, v56, v29
    v_mov_b32 v58, v56
    s_nop 1
    v_max_u32_dpp v58, v58, v58 row_ror:1 row_mask:0xf bank_mask:0xf
    s_nop 1
    v_max_u32_dpp v58, v58, v58 row_ror:2 row_mask:0xf bank_mask:0xf
    s_nop 1
    v_max_u32_dpp v58, v58, v58 row_ror:4 row_mask:0xf bank_mask:0xf
    s_nop 1
    v_max_u32_dpp v58, v58, v58 row_ror:8 row_mask:0xf bank_mask:0xf
    s_nop 1
    v_max_u32_dpp v58, v58, v58 row_bcast:15 row_mask:0xa bank_mask:0xf
    s_nop 1
    v_max_u32_dpp v58, v58, v58 row_bcast:31 row_mask:0xc bank_mask:0xf
    s_nop 0
    v_readlane_b32 s10, v58, 63
    s_nop 1
    v_cmp_eq_u32 vcc, s10, v56
    s_nop 1
    v_cndmask_b32 v58, v56, v57, vcc
    s_nop 1
    v_max_u32_dpp v58, v58, v58 row_ror:1 row_mask:0xf bank_mask:0xf
    s_nop 1
    v_max_u32_dpp v58, v58, v58 row_ror:2 row_mask:0xf bank_mask:0xf
    s_nop 1
    v_max_u32_dpp v58, v58, v58 row_ror:4 row_mask:0xf bank_mask:0xf
    s_nop 1
    v_max_u32_dpp v58, v58, v58 row_ror:8 row_mask:0xf bank_mask:0xf
    s_nop 1
    v_max_u32_dpp v58, v58, v58 row_bcast:15 row_mask:0xa bank_mask:0xf
    s_nop 1
    v_max_u32_dpp v58, v58, v58 row_bcast:31 row_mask:0xc bank_mask:0xf
    s_nop 0
    v_readlane_b32 s11, v58, 63
    s_cmp_eq_u32 s3, 4
    s_cselect_b32 s12, s10, s11
    s_and_b32 s92, s12, 0x7ff
    s_sub_u32 s92, 0x7ff, s92
    s_lshl_b32 s92, s92, 11
    buffer_load_dwordx4 v[16:19], v11, s[32:35], s92 offen
    buffer_load_dwordx4 v[20:23], v11, s[32:35], s92 offen offset:1024
    buffer_load_dwordx2 v[32:33], v8, s[32:35], s92 offen
    v_mov_b32 v12, s12
    ds_write_b32 v15, v12
    s_waitcnt vmcnt(0)
    v_mov_b32 v56, 0
    v_mov_b32 v57, 0
    v_dot2_f32_bf16 v56, v16, s94, v56
    v_dot2_f32_bf16 v57, v16, v16, v57
    v_dot2_f32_bf16 v56, v17, s94, v56
    v_dot2_f32_bf16 v57, v17, v17, v57
    v_dot2_f32_bf16 v56, v18, s94, v56
    v_dot2_f32_bf16 v57, v18, v18, v57
    v_dot2_f32_bf16 v56, v19, s94, v56
    v_dot2_f32_bf16 v57, v19, v19, v57
    v_dot2_f32_bf16 v56, v20, s94, v56
    v_dot2_f32_bf16 v57, v20, v20, v57
    v_dot2_f32_bf16 v56, v21, s94, v56
    v_dot2_f32_bf16 v57, v21, v21, v57
    v_dot2_f32_bf16 v56, v22, s94, v56
    v_dot2_f32_bf16 v57, v22, v22, v57
    v_dot2_f32_bf16 v56, v23, s94, v56
    v_dot2_f32_bf16 v57, v23, v23, v57
    s_nop 1
    v_add_f32_dpp v56, v56, v56 row_ror:1 row_mask:0xf bank_mask:0xf
    v_add_f32_dpp v57, v57, v57 row_ror:1 row_mask:0xf bank_mask:0xf
    s_nop 0
    v_add_f32_dpp v56, v56, v56 row_ror:2 row_mask:0xf bank_mask:0xf
    v_add_f32_dpp v57, v57, v57 row_ror:2 row_mask:0xf bank_mask:0xf
    s_nop 0
    v_add_f32_dpp v56, v56, v56 row_ror:4 row_mask:0xf bank_mask:0xf
    v_add_f32_dpp v57, v57, v57 row_ror:4 row_mask:0xf bank_mask:0xf
    s_nop 0
    v_add_f32_dpp v56, v56, v56 row_ror:8 row_mask:0xf bank_mask:0xf
    v_add_f32_dpp v57, v57, v57 row_ror:8 row_mask:0xf bank_mask:0xf
    s_nop 0
    v_add_f32_dpp v56, v56, v56 row_bcast:15 row_mask:0xa bank_mask:0xf
    v_add_f32_dpp v57, v57, v57 row_bcast:15 row_mask:0xa bank_mask:0xf
    s_nop 0
    v_add_f32_dpp v56, v56, v56 row_bcast:31 row_mask:0xc bank_mask:0xf
    v_add_f32_dpp v57, v57, v57 row_bcast:31 row_mask:0xc bank_mask:0xf
    v_mul_f32 v56, 0x3a800000, v56
    v_mul_f32 v57, 0x3a800000, v57
    v_fma_f32 v57, -v56, v56, v57
    v_max_f32 v57, 0, v57
    v_cvt_pk_bf16_f32 v57, v57, v57
    v_lshlrev_b32 v57, 16, v57
    v_add_f32 v57, 0x3727c5ac, v57
    v_cvt_pk_bf16_f32 v57, v57, v57
    v_lshlrev_b32 v57, 16, v57
    v_sqrt_f32 v57, v57
    v_cvt_pk_bf16_f32 v56, v56, v56
    v_lshlrev_b32 v56, 16, v56
    v_cvt_pk_bf16_f32 v57, v57, v57
    v_lshlrev_b32 v57, 16, v57
    v_rcp_f32 v57, v57
    v_readlane_b32 s4, v56, 63
    s_nop 3
    v_readlane_b32 s5, v57, 63
    v_lshlrev_b32 v60, 16, v32
    v_and_b32 v61, s93, v32
    v_subrev_f32 v60, s4, v60
    v_subrev_f32 v61, s4, v61
    v_cvt_pk_bf16_f32 v61, v60, v61
    v_lshlrev_b32 v60, 16, v61
    v_and_b32 v61, s93, v61
    v_mul_f32 v60, s5, v60
    v_mul_f32 v61, s5, v61
    v_cvt_pk_bf16_f32 v24, v60, v61
    v_lshlrev_b32 v62, 16, v33
    v_and_b32 v63, s93, v33
    v_subrev_f32 v62, s4, v62
    v_subrev_f32 v63, s4, v63
    v_cvt_pk_bf16_f32 v63, v62, v63
    v_lshlrev_b32 v62, 16, v63
    v_and_b32 v63, s93, v63
    v_mul_f32 v62, s5, v62
    v_mul_f32 v63, s5, v63
    v_cvt_pk_bf16_f32 v25, v62, v63
    ds_write_b64 v9, v[24:25]
    s_mov_b32 exec_lo, 0
    s_mov_b32 exec_hi, 0x80000000
    ds_write_b64 v14, v[56:57]
    s_branch L64
L54:
    s_waitcnt vmcnt(0)
L64:
    s_mov_b64 exec, 1
    ds_add_u32 v2, v3 offset:16
    s_mov_b64 exec, -1
    v_and_b32 v10, 1, v1
    v_lshlrev_b32 v10, 11, v10
    v_lshrrev_b32 v12, 4, v1
    v_lshl_add_u32 v10, v12, 3, v10
    s_and_b32 s12, s97, 3
    s_lshl_b32 s92, s12, 9
    s_add_u32 s92, s92, 150656
    v_add_u32 v10, s92, v10
    v_bfe_u32 v12, v1, 3, 2
    v_xor_b32 v12, s98, v12
    v_lshrrev_b32 v14, 2, v1
    v_lshl_add_u32 v12, v14, 2, v12
    v_and_b32 v14, 3, v1
    v_lshl_add_u32 v12, v12, 2, v14
    v_lshlrev_b32 v12, 3, v12
    v_add_u32 v12, 85120, v12
    s_andn2_b32 s92, s0, 0x18
    s_lshl3_add_u32 s92, s98, s92
    s_mul_i32 s92, s92, 24576
    s_lshl_b32 s12, s12, 8
    s_add_u32 s12, s12, s92
    s_add_u32 s12, s12, 23552
    s_setprio 0
    s_mov_b32 s91, 0x40000
L65:
    ds_read_b32 v4, v2 offset:16
    s_sub_u32 s91, s91, 1
    s_cbranch_scc1 L66
    s_waitcnt lgkmcnt(0)
    v_readfirstlane_b32 s92, v4
    s_cmp_lt_u32 s92, 4
    s_cbranch_scc1 L65
L66:
    s_setprio 3
    ds_read_b64 v[8:9], v13 offset:96
    s_cmp_ge_u32 s0, 224
    s_cbranch_scc1 L67
    ds_read_b64 v[16:17], v10 offset:0
    ds_read_b64_tr_b16 v[136:137], v12 offset:0
    ds_read_b64_tr_b16 v[168:169], v12 offset:32768
    ds_read_b64 v[18:19], v10 offset:32
    ds_read_b64_tr_b16 v[138:139], v12 offset:2048
    ds_read_b64_tr_b16 v[170:171], v12 offset:34816
    ds_read_b64 v[20:21], v10 offset:64
    ds_read_b64_tr_b16 v[140:141], v12 offset:4096
    ds_read_b64_tr_b16 v[172:173], v12 offset:36864
    ds_read_b64 v[22:23], v10 offset:96
    ds_read_b64_tr_b16 v[142:143], v12 offset:6144
    ds_read_b64_tr_b16 v[174:175], v12 offset:38912
    ds_read_b64 v[24:25], v10 offset:128
    ds_read_b64_tr_b16 v[144:145], v12 offset:8192
    ds_read_b64_tr_b16 v[176:177], v12 offset:40960
    ds_read_b64 v[26:27], v10 offset:160
    ds_read_b64_tr_b16 v[146:147], v12 offset:10240
    ds_read_b64_tr_b16 v[178:179], v12 offset:43008
    ds_read_b64 v[28:29], v10 offset:192
    ds_read_b64_tr_b16 v[148:149], v12 offset:12288
    ds_read_b64_tr_b16 v[180:181], v12 offset:45056
    ds_read_b64 v[30:31], v10 offset:224
    ds_read_b64_tr_b16 v[150:151], v12 offset:14336
    ds_read_b64_tr_b16 v[182:183], v12 offset:47104
    ds_read_b64 v[32:33], v10 offset:256
    ds_read_b64_tr_b16 v[152:153], v12 offset:16384
    ds_read_b64_tr_b16 v[184:185], v12 offset:49152
    ds_read_b64 v[34:35], v10 offset:288
    ds_read_b64_tr_b16 v[154:155], v12 offset:18432
    ds_read_b64_tr_b16 v[186:187], v12 offset:51200
    ds_read_b64 v[36:37], v10 offset:320
    ds_read_b64_tr_b16 v[156:157], v12 offset:20480
    ds_read_b64_tr_b16 v[188:189], v12 offset:53248
    ds_read_b64 v[38:39], v10 offset:352
    ds_read_b64_tr_b16 v[158:159], v12 offset:22528
    ds_read_b64_tr_b16 v[190:191], v12 offset:55296
    ds_read_b64 v[40:41], v10 offset:384
    ds_read_b64_tr_b16 v[160:161], v12 offset:24576
    ds_read_b64_tr_b16 v[192:193], v12 offset:57344
    ds_read_b64 v[42:43], v10 offset:416
    ds_read_b64_tr_b16 v[162:163], v12 offset:26624
    ds_read_b64_tr_b16 v[194:195], v12 offset:59392
    ds_read_b64 v[44:45], v10 offset:448
    ds_read_b64_tr_b16 v[164:165], v12 offset:28672
    ds_read_b64_tr_b16 v[196:197], v12 offset:61440
    ds_read_b64 v[46:47], v10 offset:480
    ds_read_b64_tr_b16 v[166:167], v12 offset:30720
    ds_read_b64_tr_b16 v[198:199], v12 offset:63488
    s_waitcnt lgkmcnt(0)
    v_mfma_f32_16x16x32_bf16 v[48:51], v[16:19], v[136:139], 0
    v_mfma_f32_16x16x32_bf16 v[52:55], v[16:19], v[168:171], 0
    v_mfma_f32_16x16x32_bf16 v[48:51], v[20:23], v[140:143], v[48:51]
    v_mfma_f32_16x16x32_bf16 v[52:55], v[20:23], v[172:175], v[52:55]
    v_mfma_f32_16x16x32_bf16 v[48:51], v[24:27], v[144:147], v[48:51]
    v_mfma_f32_16x16x32_bf16 v[52:55], v[24:27], v[176:179], v[52:55]
    v_mfma_f32_16x16x32_bf16 v[48:51], v[28:31], v[148:151], v[48:51]
    v_mfma_f32_16x16x32_bf16 v[52:55], v[28:31], v[180:183], v[52:55]
    v_mfma_f32_16x16x32_bf16 v[48:51], v[32:35], v[152:155], v[48:51]
    v_mfma_f32_16x16x32_bf16 v[52:55], v[32:35], v[184:187], v[52:55]
    v_mfma_f32_16x16x32_bf16 v[48:51], v[36:39], v[156:159], v[48:51]
    v_mfma_f32_16x16x32_bf16 v[52:55], v[36:39], v[188:191], v[52:55]
    v_mfma_f32_16x16x32_bf16 v[48:51], v[40:43], v[160:163], v[48:51]
    v_mfma_f32_16x16x32_bf16 v[52:55], v[40:43], v[192:195], v[52:55]
    v_mfma_f32_16x16x32_bf16 v[48:51], v[44:47], v[164:167], v[48:51]
    v_mfma_f32_16x16x32_bf16 v[52:55], v[44:47], v[196:199], v[52:55]
    s_nop 7
    v_mov_b32 v50, v52
    v_mov_b32 v51, v53
    s_mov_b64 exec, 0xffff
    buffer_store_dwordx4 v[48:51], v11, s[56:59], s12 offen sc1
    s_mov_b64 exec, 1
    ds_add_u32 v2, v3 offset:20
    s_mov_b64 exec, -1
    s_setprio 0
    s_cmp_lg_u32 s3, 4
    s_cbranch_scc1 L67
    v_and_b32 v14, 15, v1
    v_lshlrev_b32 v10, 4, v14
    v_lshlrev_b32 v14, 3, v14
    v_add_u32 v14, 160032, v14
    s_mul_i32 s12, s0, 24576
    s_add_u32 s12, s12, 23552
    s_mov_b32 s91, 8192
    buffer_load_dwordx4 v[16:19], v10, s[56:59], s12 offen offset:0 sc1
    buffer_load_dwordx4 v[20:23], v10, s[56:59], s12 offen offset:256 sc1
    buffer_load_dwordx4 v[24:27], v10, s[56:59], s12 offen offset:512 sc1
    buffer_load_dwordx4 v[28:31], v10, s[56:59], s12 offen offset:768 sc1
    s_branch L69
L68:
    s_mov_b64 exec, s[20:21]
    s_cbranch_execz L71
    buffer_load_dwordx4 v[16:19], v10, s[56:59], s12 offen offset:0 sc1
L71:
    s_mov_b64 exec, s[22:23]
    s_cbranch_execz L72
    buffer_load_dwordx4 v[20:23], v10, s[56:59], s12 offen offset:256 sc1
L72:
    s_mov_b64 exec, s[24:25]
    s_cbranch_execz L73
    buffer_load_dwordx4 v[24:27], v10, s[56:59], s12 offen offset:512 sc1
L73:
    s_mov_b64 exec, s[26:27]
    s_cbranch_execz L74
    buffer_load_dwordx4 v[28:31], v10, s[56:59], s12 offen offset:768 sc1
L74:
    s_mov_b64 exec, -1
L69:
    s_sub_u32 s91, s91, 1
    s_waitcnt vmcnt(0)
    s_cbranch_scc1 L70
    v_max_u32 v32, v16, v17
    v_max3_u32 v32, v32, v18, v19
    v_max_u32 v33, v20, v21
    v_max3_u32 v33, v33, v22, v23
    v_max_u32 v34, v24, v25
    v_max3_u32 v34, v34, v26, v27
    v_max_u32 v35, v28, v29
    v_max3_u32 v35, v35, v30, v31
    v_cmp_eq_u32 s[20:21], -1, v32
    v_cmp_eq_u32 s[22:23], -1, v33
    v_cmp_eq_u32 s[24:25], -1, v34
    v_cmp_eq_u32 s[26:27], -1, v35
    s_or_b64 vcc, s[20:21], s[22:23]
    s_or_b64 vcc, vcc, s[24:25]
    s_or_b64 vcc, vcc, s[26:27]
    s_cbranch_scc1 L68
L70:
    s_setprio 3
    v_pk_add_f32 v[16:17], v[16:17], v[20:21]
    v_pk_add_f32 v[18:19], v[18:19], v[22:23]
    v_pk_add_f32 v[24:25], v[24:25], v[28:29]
    v_pk_add_f32 v[26:27], v[26:27], v[30:31]
    v_pk_add_f32 v[16:17], v[16:17], v[24:25]
    v_pk_add_f32 v[18:19], v[18:19], v[26:27]
    v_cvt_pk_bf16_f32 v16, v16, v16
    v_lshlrev_b32 v16, 16, v16
    v_cvt_pk_bf16_f32 v17, v17, v17
    v_lshlrev_b32 v17, 16, v17
    v_cvt_pk_bf16_f32 v18, v18, v18
    v_lshlrev_b32 v18, 16, v18
    v_cvt_pk_bf16_f32 v19, v19, v19
    v_lshlrev_b32 v19, 16, v19
    v_mul_f32 v20, 0xbfb8aa3b, v16
    v_exp_f32 v20, v20
    s_nop 0
    v_add_f32 v20, 1.0, v20
    v_rcp_f32 v20, v20
    s_nop 0
    v_mul_f32 v16, v16, v20
    v_cvt_pk_bf16_f32 v16, v16, v16
    v_lshlrev_b32 v16, 16, v16
    v_mul_f32 v16, v16, v18
    v_cvt_pk_bf16_f32 v16, v16, v16
    v_lshlrev_b32 v16, 16, v16
    v_mul_f32 v21, 0xbfb8aa3b, v17
    v_exp_f32 v21, v21
    s_nop 0
    v_add_f32 v21, 1.0, v21
    v_rcp_f32 v21, v21
    s_nop 0
    v_mul_f32 v17, v17, v21
    v_cvt_pk_bf16_f32 v17, v17, v17
    v_lshlrev_b32 v17, 16, v17
    v_mul_f32 v17, v17, v19
    v_cvt_pk_bf16_f32 v17, v17, v17
    v_lshlrev_b32 v17, 16, v17
    ds_write_b64 v14, v[16:17]
    s_mov_b64 exec, 1
    ds_add_u32 v2, v3 offset:24
    s_mov_b64 exec, -1
L67:
    s_waitcnt lgkmcnt(0)
    v_readfirstlane_b32 s10, v8
    v_readfirstlane_b32 s11, v9
    s_lshl_b32 s92, s2, 3
    s_sub_u32 s92, 0x7ff, s92
    s_and_b32 s10, s10, 0x7ff
    s_and_b32 s11, s11, 0x7ff
    s_sub_u32 s10, s92, s10
    s_sub_u32 s11, s92, s11
    s_min_u32 s10, s10, 31
    s_min_u32 s11, s11, 31
    s_lshl_b32 s10, 1, s10
    s_bitset1_b32 s10, s11
    v_lshrrev_b32 v8, 2, v0
    v_mul_u32_u24 v8, 98304, v8
    v_and_b32 v9, 3, v0
    s_lshl_b32 s92, s2, 6
    v_lshl_add_u32 v9, v9, 4, s92
    v_add_u32 v8, v8, v9
    s_mov_b32 s4, 24576
    s_mov_b32 s5, 49152
    s_mov_b32 s6, 73728
    v_lshlrev_b32 v10, 4, v0
    v_add_u32 v10, 154752, v10
    s_setprio 0
    s_barrier
    ds_read_b128 v[48:51], v10
    s_waitcnt lgkmcnt(0)
    s_mov_b32 s91, 8192
    buffer_load_dwordx4 v[16:19], v8, s[56:59], 0 offen sc1
    buffer_load_dwordx4 v[20:23], v8, s[56:59], s4 offen sc1
    buffer_load_dwordx4 v[24:27], v8, s[56:59], s5 offen sc1
    buffer_load_dwordx4 v[28:31], v8, s[56:59], s6 offen sc1
    s_branch L77
L76:
    s_mov_b64 exec, s[20:21]
    s_cbranch_execz L79
    buffer_load_dwordx4 v[16:19], v8, s[56:59], 0 offen sc1
L79:
    s_mov_b64 exec, s[22:23]
    s_cbranch_execz L80
    buffer_load_dwordx4 v[20:23], v8, s[56:59], s4 offen sc1
L80:
    s_mov_b64 exec, s[24:25]
    s_cbranch_execz L81
    buffer_load_dwordx4 v[24:27], v8, s[56:59], s5 offen sc1
L81:
    s_mov_b64 exec, s[26:27]
    s_cbranch_execz L82
    buffer_load_dwordx4 v[28:31], v8, s[56:59], s6 offen sc1
L82:
    s_mov_b64 exec, -1
L77:
    s_sub_u32 s91, s91, 1
    s_waitcnt vmcnt(0)
    s_cbranch_scc1 L78
    v_cmp_eq_u32 s[20:21], v48, v16
    v_cmp_eq_u32 s[22:23], v49, v20
    v_cmp_eq_u32 s[24:25], v50, v24
    v_cmp_eq_u32 s[26:27], v51, v28
    s_or_b64 vcc, s[20:21], s[22:23]
    s_or_b64 vcc, vcc, s[24:25]
    s_or_b64 vcc, vcc, s[26:27]
    s_cbranch_scc1 L76
L78:
    s_mov_b64 exec, 1
    ds_add_u32 v2, v3 offset:12
    s_mov_b64 exec, -1
    v_lshlrev_b32 v56, 16, v16
    v_lshlrev_b32 v57, 16, v20
    v_lshlrev_b32 v58, 16, v24
    v_lshlrev_b32 v59, 16, v28
    v_pk_fma_f32 v[56:57], v[56:57], v[104:105], v[72:73]
    v_pk_fma_f32 v[58:59], v[58:59], v[106:107], v[74:75]
    v_cvt_pk_bf16_f32 v32, v56, v57
    v_cvt_pk_bf16_f32 v33, v58, v59
    s_bitcmp1_b32 s10, 0
    s_cbranch_scc1 L83
    buffer_store_dwordx2 v[32:33], v6, s[84:87], 0 offen
L83:
    v_and_b32 v60, s93, v16
    v_and_b32 v61, s93, v20
    v_and_b32 v62, s93, v24
    v_and_b32 v63, s93, v28
    v_pk_fma_f32 v[60:61], v[60:61], v[108:109], v[76:77]
    v_pk_fma_f32 v[62:63], v[62:63], v[110:111], v[78:79]
    v_cvt_pk_bf16_f32 v34, v60, v61
    v_cvt_pk_bf16_f32 v35, v62, v63
    s_bitcmp1_b32 s10, 1
    s_cbranch_scc1 L84
    buffer_store_dwordx2 v[34:35], v6, s[84:87], 0 offen offset:2048
L84:
    v_lshlrev_b32 v56, 16, v17
    v_lshlrev_b32 v57, 16, v21
    v_lshlrev_b32 v58, 16, v25
    v_lshlrev_b32 v59, 16, v29
    v_pk_fma_f32 v[56:57], v[56:57], v[112:113], v[80:81]
    v_pk_fma_f32 v[58:59], v[58:59], v[114:115], v[82:83]
    v_cvt_pk_bf16_f32 v36, v56, v57
    v_cvt_pk_bf16_f32 v37, v58, v59
    s_bitcmp1_b32 s10, 2
    s_cbranch_scc1 L85
    buffer_store_dwordx2 v[36:37], v6, s[84:87], s88 offen
L85:
    v_and_b32 v60, s93, v17
    v_and_b32 v61, s93, v21
    v_and_b32 v62, s93, v25
    v_and_b32 v63, s93, v29
    v_pk_fma_f32 v[60:61], v[60:61], v[116:117], v[84:85]
    v_pk_fma_f32 v[62:63], v[62:63], v[118:119], v[86:87]
    v_cvt_pk_bf16_f32 v38, v60, v61
    v_cvt_pk_bf16_f32 v39, v62, v63
    s_bitcmp1_b32 s10, 3
    s_cbranch_scc1 L86
    buffer_store_dwordx2 v[38:39], v6, s[84:87], s88 offen offset:2048
L86:
    v_lshlrev_b32 v56, 16, v18
    v_lshlrev_b32 v57, 16, v22
    v_lshlrev_b32 v58, 16, v26
    v_lshlrev_b32 v59, 16, v30
    v_pk_fma_f32 v[56:57], v[56:57], v[120:121], v[88:89]
    v_pk_fma_f32 v[58:59], v[58:59], v[122:123], v[90:91]
    v_cvt_pk_bf16_f32 v40, v56, v57
    v_cvt_pk_bf16_f32 v41, v58, v59
    s_bitcmp1_b32 s10, 4
    s_cbranch_scc1 L87
    buffer_store_dwordx2 v[40:41], v6, s[84:87], s89 offen
L87:
    v_and_b32 v60, s93, v18
    v_and_b32 v61, s93, v22
    v_and_b32 v62, s93, v26
    v_and_b32 v63, s93, v30
    v_pk_fma_f32 v[60:61], v[60:61], v[124:125], v[92:93]
    v_pk_fma_f32 v[62:63], v[62:63], v[126:127], v[94:95]
    v_cvt_pk_bf16_f32 v42, v60, v61
    v_cvt_pk_bf16_f32 v43, v62, v63
    s_bitcmp1_b32 s10, 5
    s_cbranch_scc1 L88
    buffer_store_dwordx2 v[42:43], v6, s[84:87], s89 offen offset:2048
L88:
    v_lshlrev_b32 v56, 16, v19
    v_lshlrev_b32 v57, 16, v23
    v_lshlrev_b32 v58, 16, v27
    v_lshlrev_b32 v59, 16, v31
    v_pk_fma_f32 v[56:57], v[56:57], v[128:129], v[96:97]
    v_pk_fma_f32 v[58:59], v[58:59], v[130:131], v[98:99]
    v_cvt_pk_bf16_f32 v44, v56, v57
    v_cvt_pk_bf16_f32 v45, v58, v59
    s_bitcmp1_b32 s10, 6
    s_cbranch_scc1 L89
    buffer_store_dwordx2 v[44:45], v6, s[84:87], s90 offen
L89:
    v_and_b32 v60, s93, v19
    v_and_b32 v61, s93, v23
    v_and_b32 v62, s93, v27
    v_and_b32 v63, s93, v31
    v_pk_fma_f32 v[60:61], v[60:61], v[132:133], v[100:101]
    v_pk_fma_f32 v[62:63], v[62:63], v[134:135], v[102:103]
    v_cvt_pk_bf16_f32 v46, v60, v61
    v_cvt_pk_bf16_f32 v47, v62, v63
    s_bitcmp1_b32 s10, 7
    s_cbranch_scc1 L90
    buffer_store_dwordx2 v[46:47], v6, s[84:87], s90 offen offset:2048
L90:
L_fin:
L_end:
    s_endpgm
.section .rodata,"a"
.p2align 6
.amdhsa_kernel recurrent_scan__ssm_conv_h3__moe_arch_mod__prompt_kernel
  .amdhsa_next_free_vgpr 216
  .amdhsa_next_free_sgpr 102
  .amdhsa_accum_offset 216
  .amdhsa_group_segment_fixed_size 0
  .amdhsa_kernarg_size 112
  .amdhsa_user_sgpr_count 2
  .amdhsa_user_sgpr_kernarg_segment_ptr 1
  .amdhsa_system_sgpr_workgroup_id_x 1
.end_amdhsa_kernel
```
